```python
import torch

def _softmax(x, axis=-1):
    return torch.softmax(x, dim=axis)
def _gelu(x):
    return torch.nn.functional.gelu(x, approximate="tanh")
def _silu(x):
    return torch.nn.functional.silu(x)
def _sigmoid(x):
    return torch.sigmoid(x)
def _layernorm(x, axis=-1, eps=1e-5):
    m = x.mean(dim=axis, keepdim=True)
    v = x.var(dim=axis, keepdim=True, unbiased=False)
    return (x - m) / torch.sqrt(v + eps)
def _scatter_add(tgt, idx, src, axis=0):
    return tgt.clone().index_add_(axis, idx, src)
def _segment_sum(src, seg, n):
    out = torch.zeros((n,) + src.shape[1:], dtype=src.dtype)
    return out.index_add_(0, seg, src)
def _pad(x, pw):
    flat = tuple(v for pair in reversed(pw) for v in pair)
    return torch.nn.functional.pad(x, flat)

kernel_name = 'parallel_sum__sliding_block_cached__glu_gated_geglu__decode'

def setup_inputs():

    _w = (lambda a: (lambda t: t.to(torch.bfloat16) if t.is_floating_point() else t)(torch.as_tensor(a)))
    def _A_setup():
        B, Sq, D = 1, 1, 512
        Hq, Hkv, Sk, Dh = 32, 8, 32768, 128
        assert Hq % Hkv == 0, (Hq, Hkv)
        return {
            "x": _w((lambda *s: torch.randn(*s, dtype=torch.bfloat16) * 0.05)(B, Sq, D)),
            "k_cache": _w((lambda *s: torch.randn(*s, dtype=torch.bfloat16) * 1.6)(B, Hkv, Sk, Dh)),
            "v_cache": _w((lambda *s: torch.randn(*s, dtype=torch.bfloat16) * 0.8)(B, Hkv, Sk, Dh)),
            "wq": _w((lambda *s: torch.randn(*s, dtype=torch.bfloat16) * 1.6)(D, Hq * Dh) * (D ** -0.5)),
            "wo": _w((lambda *s: torch.randn(*s, dtype=torch.bfloat16) * 0.8)(Hq * Dh, D) * ((Hq * Dh) ** -0.5)),
        }
    _A_in = _A_setup()

    def _B_setup():
        B, S, Dm, Df = 1, 1, 512, 1792
        return {
            "x": _w((lambda *s: torch.randn(*s, dtype=torch.bfloat16) * 0.05)(B, S, Dm)),
            "w_gate": _w((lambda *s: torch.randn(*s, dtype=torch.bfloat16) * 0.8)(Dm, Df) * (Dm ** -0.5)),
            "w_up": _w((lambda *s: torch.randn(*s, dtype=torch.bfloat16) * 0.8)(Dm, Df) * (Dm ** -0.5)),
            "w_down": _w((lambda *s: torch.randn(*s, dtype=torch.bfloat16) * 0.8)(Df, Dm) * (Df ** -0.5)),
        }
    _B_in = _B_setup()

    return {
        "A_x": _A_in["x"],
        "A_k_cache": _A_in["k_cache"],
        "A_v_cache": _A_in["v_cache"],
        "A_wq": _A_in["wq"],
        "A_wo": _A_in["wo"],
        "B_x": _B_in["x"],
        "B_w_gate": _B_in["w_gate"],
        "B_w_up": _B_in["w_up"],
        "B_w_down": _B_in["w_down"],
    }

def reference(A_x, A_k_cache, A_v_cache, A_wq, A_wo, B_x, B_w_gate, B_w_up, B_w_down):
    def _A_ref(x, k_cache, v_cache, wq, wo):
        B, Sq, D = x.shape
        Hq, Dh = 32, 128
        Hkv, Sk = k_cache.shape[1], k_cache.shape[2]
        W = min(4096, max(256, Sk // 4))
        rep = Hq // Hkv
        q = (lambda x, *d: x.permute(*d))((x @ wq).reshape(B, Sq, Hq, Dh), 0, 2, 1, 3)
        k = (lambda x, n, axis: torch.repeat_interleave(x, n, dim=axis))(k_cache[:, :, Sk - W:, :], rep, axis=1)
        v = (lambda x, n, axis: torch.repeat_interleave(x, n, dim=axis))(v_cache[:, :, Sk - W:, :], rep, axis=1)
        scores = torch.einsum("bhqd,bhkd->bhqk", q, k) * (Dh ** -0.5)
        p = _softmax(scores, axis=-1)
        o = torch.einsum("bhqk,bhkd->bhqd", p, v)
        return (lambda x, *d: x.permute(*d))(o, 0, 2, 1, 3).reshape(B, Sq, Hq * Dh) @ wo

    def _B_ref(x, w_gate, w_up, w_down):
        g = torch.einsum("bsd,df->bsf", x, w_gate)
        u = torch.einsum("bsd,df->bsf", x, w_up)
        h = _gelu(g) * u
        return torch.einsum("bsf,fd->bsd", h, w_down)

    x = A_x
    xn = _layernorm(x, axis=-1)
    return x + _A_ref(xn, A_k_cache, A_v_cache, A_wq, A_wo) + _B_ref(xn, B_w_gate, B_w_up, B_w_down)
```

```asm
; @launch grid=(256,1,1) block=(256,1,1) lds=22016
.amdgcn_target "amdgcn-amd-amdhsa--gfx950"
.text
.globl parallel_sum__sliding_block_cached__glu_gated_geglu__decode_kernel
.p2align 8
.type parallel_sum__sliding_block_cached__glu_gated_geglu__decode_kernel,@function
parallel_sum__sliding_block_cached__glu_gated_geglu__decode_kernel:
    s_load_dwordx16 s[4:19], s[0:1], 0
    s_load_dwordx8 s[20:27], s[0:1], 64
    s_cmpk_ge_u32 s2, 256
    s_cbranch_scc1 L_end
    s_getpc_b64 s[38:39]
    s_lshr_b32 s29, s2, 3
    s_lshl_b32 s34, s29, 9
    v_lshl_add_u32 v40, v0, 1, s34
    global_load_ushort v252, v40, s[38:39]
    v_and_b32 v1, 63, v0
    v_lshlrev_b32 v9, 4, v1
    v_lshrrev_b32 v47, 3, v0
    s_and_b32 s34, s2, 24
    s_lshl_b32 s34, s34, 2
    v_add_u32 v47, s34, v47
    v_lshlrev_b32 v10, 3, v47
    v_and_b32 v42, 7, v0
    s_and_b32 s28, s2, 7
    s_lshr_b32 s36, s2, 5
    s_xor_b32 s33, s36, 3
    s_lshl3_add_u32 s35, s28, s33
    s_lshl_b32 s35, s35, 7
    v_lshl_add_u32 v20, v42, 4, s35
    v_lshl_add_u32 v20, v47, 15, v20
    s_movk_i32 s34, 0x2000
    v_add_u32 v21, s34, v20
    v_add_u32 v22, s34, v21
    v_add_u32 v23, s34, v22
    s_getreg_b32 s53, hwreg(HW_REG_XCC_ID, 0, 4)
    s_bitset1_b32 s53, 7
    v_mov_b32 v49, s2
    v_mov_b32 v50, s53
    v_and_b32 v51, 31, v0
    v_lshl_add_u32 v254, v51, 3, s28
    v_lshlrev_b32 v0, 2, v1
    v_mov_b32 v51, 0
    ds_write_b32 v0, v51 offset:21760
    s_waitcnt lgkmcnt(0)
    global_load_dwordx4 v[52:55], v9, s[4:5]
    global_load_dwordx2 v[56:57], v10, s[4:5]
    global_store_byte v49, v50, s[24:25]
    s_barrier
    global_load_ubyte v255, v254, s[24:25] sc1
    global_load_dwordx4 v[64:67], v20, s[10:11] nt
    global_load_dwordx4 v[68:71], v21, s[10:11] nt
    global_load_dwordx4 v[72:75], v22, s[10:11] nt
    global_load_dwordx4 v[76:79], v23, s[10:11] nt
L_entry_end:
    s_load_dword s44, s[26:27], 0
    v_readfirstlane_b32 s30, v47
    s_and_b32 s31, s29, 3
    s_bfe_u32 s30, s30, 0x20003
    s_xor_b32 s36, s33, 4
    s_mul_i32 s34, s28, 3
    s_lshr_b32 s35, s36, 1
    s_add_u32 s34, s34, s35
    s_lshr_b32 s35, s28, 1
    s_add_u32 s35, s35, 24
    s_cmp_lt_u32 s36, 6
    s_cselect_b32 s34, s34, s35
    s_cselect_b32 s51, s36, s28
    s_and_b32 s51, s51, 1
    s_cselect_b32 s16, s18, s16
    s_cselect_b32 s17, s19, s17
    s_lshl_b32 s35, s34, 7
    s_addk_i32 s35, 3584
    v_lshl_add_u32 v24, v42, 4, s35
    s_movk_i32 s35, 14336
    v_mad_u32_u24 v24, v47, s35, v24
    v_add_u32 v25, 7168, v24
    s_lshl_b32 s37, s30, 6
    s_lshl2_add_u32 s46, s28, s31
    s_lshl3_add_u32 s46, s46, s33
    s_lshl_b32 s46, s46, 8
    s_addk_i32 s46, 8192
    s_lshl1_add_u32 s47, s34, s51
    s_lshl2_add_u32 s47, s47, s31
    s_lshl_b32 s47, s47, 8
    s_add_u32 s47, s47, 73728
    s_lshl2_add_u32 s35, s28, s30
    s_lshl_b32 s35, s35, 5
    s_add_u32 s35, s35, s29
    s_lshl_b32 s50, s35, 9
    s_add_u32 s50, s50, 262144
    s_lshl_b32 s49, s35, 4
    s_add_u32 s49, s49, 131072
    v_lshl_add_u32 v10, v1, 7, s50
    v_writelane_b32 v10, s49, 4
    s_cmp_lt_u32 s30, 2
    s_cselect_b32 s34, s46, s47
    s_and_b32 s35, s37, 64
    s_lshl1_add_u32 s34, s35, s34
    v_writelane_b32 v10, s34, 5
    s_mov_b64 exec, 63
    global_load_dword v252, v10, s[26:27] sc1
    s_mov_b64 exec, -1
    v_lshrrev_b32 v41, 3, v1
    s_lshl_b32 s35, s33, 11
    s_add_u32 s35, s35, 147456
    v_lshl_add_u32 v18, v42, 3, s35
    v_lshl_add_u32 v18, v41, 8, v18
    v_lshrrev_b32 v43, 4, v1
    v_and_b32 v44, 1, v41
    v_and_b32 v45, 3, v1
    v_bfe_u32 v46, v1, 2, 2
    v_lshlrev_b32 v2, 4, v45
    v_mov_b32 v3, 0xff
    s_lshl_b32 s34, s28, 23
    s_and_b32 s35, s29, 7
    s_lshl3_add_u32 s35, s29, s35
    s_lshl2_add_u32 s35, s35, s30
    s_lshl_b32 s35, s35, 10
    s_add_u32 s34, s34, s35
    s_add_u32 s34, s34, 7340032
    v_add_u32 v12, s34, v9
    v_lshl_add_u32 v11, v46, 8, v2
    v_lshl_add_u32 v11, v43, 6, v11
    v_add_u32 v11, s34, v11
    v_and_b32 v50, 1, v1
    v_lshlrev_b32 v50, 4, v50
    v_mov_b32 v51, 0xffff
    v_lshlrev_b32 v50, v50, v51
    v_lshrrev_b32_e64 v49, 1, v42
    v_cmp_eq_u32 s[90:91], 0, v49
    v_cmp_eq_u32 s[92:93], 1, v49
    v_cmp_eq_u32 s[94:95], 2, v49
    v_cmp_eq_u32 s[96:97], 3, v49
    v_cndmask_b32 v4, 0, v50, s[90:91]
    v_cndmask_b32 v5, 0, v50, s[92:93]
    v_cndmask_b32 v6, 0, v50, s[94:95]
    v_cndmask_b32 v7, 0, v50, s[96:97]
    v_lshrrev_b32 v50, 5, v1
    v_xor_b32 v51, v50, v44
    v_lshlrev_b32 v30, 11, v51
    v_lshl_add_u32 v30, v44, 8, v30
    v_lshl_add_u32 v30, v42, 5, v30
    v_and_or_b32 v30, v1, 16, v30
    s_lshl_b32 s34, s30, 9
    v_add_u32 v30, s34, v30
    s_mov_b32 s45, 0
    s_mov_b32 s59, 0
    s_lshl_b32 s34, s33, 7
    v_lshl_add_u32 v19, v1, 1, s34
    s_addk_i32 s34, 1024
    v_mov_b32 v22, s34
    v_and_b32 v37, 0x1f0, v9
    v_and_b32 v50, 32, v1
    v_lshl_add_u32 v14, v50, 6, v37
    s_lshl4_add_u32 s35, s28, s30
    s_lshl_b32 s35, s35, 9
    s_addk_i32 s35, 12288
    v_add_u32 v14, s35, v14
    s_cmp_eq_u32 s33, 3
    s_cbranch_scc1 L_front_I
    s_waitcnt vmcnt(7)
    global_load_dwordx4 v[80:83], v24, s[16:17] offset:-3584 nt
    global_load_dwordx4 v[84:87], v24, s[16:17] offset:0 nt
    v_lshlrev_b32 v144, 16, v52
    v_and_b32 v145, 0xffff0000, v52
    v_lshlrev_b32 v146, 16, v53
    v_and_b32 v147, 0xffff0000, v53
    v_lshlrev_b32 v148, 16, v54
    v_and_b32 v149, 0xffff0000, v54
    v_lshlrev_b32 v150, 16, v55
    v_and_b32 v151, 0xffff0000, v55
    v_pk_add_f32 v[40:41], v[144:145], v[146:147]
    v_pk_add_f32 v[42:43], v[148:149], v[150:151]
    v_pk_add_f32 v[40:41], v[40:41], v[42:43]
    v_add_f32 v40, v40, v41
    v_lshlrev_b32 v152, 16, v56
    v_and_b32 v153, 0xffff0000, v56
    v_add_f32_dpp v40, v40, v40 quad_perm:[1,0,3,2] row_mask:0xf bank_mask:0xf
    v_lshlrev_b32 v154, 16, v57
    v_and_b32 v155, 0xffff0000, v57
    v_add_f32_dpp v40, v40, v40 quad_perm:[2,3,0,1] row_mask:0xf bank_mask:0xf
    s_nop 1
    v_add_f32_dpp v40, v40, v40 row_half_mirror row_mask:0xf bank_mask:0xf
    s_nop 1
    v_add_f32_dpp v40, v40, v40 row_ror:8 row_mask:0xf bank_mask:0xf
    v_mov_b32 v41, v40
    s_nop 1
    v_permlane16_swap_b32 v41, v40
    v_add_f32 v40, v41, v40
    v_mov_b32 v41, v40
    s_nop 1
    v_permlane32_swap_b32 v41, v40
    v_add_f32_e64 v40, v41, v40
    v_mul_f32 v40, 0x3b000000, v40
    v_pk_add_f32 v[144:145], v[144:145], v[40:41] op_sel_hi:[1,0] neg_lo:[0,1] neg_hi:[0,1]
    v_pk_add_f32 v[146:147], v[146:147], v[40:41] op_sel_hi:[1,0] neg_lo:[0,1] neg_hi:[0,1]
    v_pk_add_f32 v[148:149], v[148:149], v[40:41] op_sel_hi:[1,0] neg_lo:[0,1] neg_hi:[0,1]
    v_pk_add_f32 v[150:151], v[150:151], v[40:41] op_sel_hi:[1,0] neg_lo:[0,1] neg_hi:[0,1]
    v_pk_mul_f32 v[42:43], v[144:145], v[144:145]
    v_pk_fma_f32 v[42:43], v[146:147], v[146:147], v[42:43]
    v_pk_fma_f32 v[42:43], v[148:149], v[148:149], v[42:43]
    v_pk_fma_f32 v[42:43], v[150:151], v[150:151], v[42:43]
    v_add_f32_e64 v42, v42, v43
    v_cvt_pk_bf16_f32 v40, v40, v40
    v_and_b32 v40, 0xffff0000, v40
    v_add_f32_dpp v42, v42, v42 quad_perm:[1,0,3,2] row_mask:0xf bank_mask:0xf
    v_pk_add_f32 v[152:153], v[152:153], v[40:41] op_sel_hi:[1,0] neg_lo:[0,1] neg_hi:[0,1]
    v_pk_add_f32 v[154:155], v[154:155], v[40:41] op_sel_hi:[1,0] neg_lo:[0,1] neg_hi:[0,1]
    v_add_f32_dpp v42, v42, v42 quad_perm:[2,3,0,1] row_mask:0xf bank_mask:0xf
    v_cvt_pk_bf16_f32 v44, v152, v153
    v_cvt_pk_bf16_f32 v45, v154, v155
    v_add_f32_dpp v42, v42, v42 row_half_mirror row_mask:0xf bank_mask:0xf
    v_lshlrev_b32 v152, 16, v44
    v_and_b32 v153, 0xffff0000, v44
    v_add_f32_dpp v42, v42, v42 row_ror:8 row_mask:0xf bank_mask:0xf
    v_mov_b32 v41, v42
    v_lshlrev_b32 v154, 16, v45
    v_and_b32 v155, 0xffff0000, v45
    v_permlane16_swap_b32 v41, v42
    v_add_f32 v42, v41, v42
    v_mov_b32 v41, v42
    s_nop 1
    v_permlane32_swap_b32 v41, v42
    v_add_f32 v42, v41, v42
    v_mul_f32 v42, 0x3b000000, v42
    v_cvt_pk_bf16_f32 v42, 0, v42
    v_add_f32 v42, 0x3727c5ac, v42
    v_cvt_pk_bf16_f32 v42, 0, v42
    v_sqrt_f32 v42, v42
    s_nop 0
    v_cvt_pk_bf16_f32 v42, 0, v42
    v_rcp_f32_e64 v42, v42
    s_nop 0
    v_pk_mul_f32 v[152:153], v[152:153], v[42:43] op_sel_hi:[1,0]
    v_pk_mul_f32 v[154:155], v[154:155], v[42:43] op_sel_hi:[1,0]
    v_cvt_pk_bf16_f32 v152, v152, v152
    v_cvt_pk_bf16_f32 v153, v153, v153
    v_cvt_pk_bf16_f32 v154, v154, v154
    v_cvt_pk_bf16_f32 v155, v155, v155
    v_and_b32 v96, v152, v4
    v_and_b32 v97, v152, v5
    v_and_b32 v98, v152, v6
    v_and_b32 v99, v152, v7
    v_and_b32 v100, v153, v4
    v_and_b32 v101, v153, v5
    v_and_b32 v102, v153, v6
    v_and_b32 v103, v153, v7
    v_and_b32 v104, v154, v4
    v_and_b32 v105, v154, v5
    v_and_b32 v106, v154, v6
    v_and_b32 v107, v154, v7
    v_and_b32 v108, v155, v4
    v_and_b32 v109, v155, v5
    v_and_b32 v110, v155, v6
    v_and_b32 v111, v155, v7
    s_waitcnt vmcnt(5)
    global_load_dwordx4 v[88:91], v24, s[16:17] offset:3584 nt
    global_load_dwordx4 v[92:95], v25, s[16:17] offset:0 nt
    v_mfma_f32_16x16x32_bf16 v[240:243], v[96:99], v[64:67], 0
    v_mfma_f32_16x16x32_bf16 v[240:243], v[100:103], v[68:71], v[240:243]
    s_waitcnt lgkmcnt(0)
    s_add_u32 s44, s44, 0x9e3779b1
    s_bfe_u32 s40, s44, 524288
    s_bfe_u32 s41, s44, 524296
    s_bfe_u32 s42, s44, 524304
    s_bfe_u32 s43, s44, 524312
    v_lshrrev_b32 v23, 1, v2
    v_lshrrev_b32 v23, v23, s44
    v_cmp_ne_u32 vcc, s53, v255
    s_nop 0
    s_cmp_eq_u64 vcc, 0
    s_cselect_b32 s54, 1, 0
    s_cmp_lg_u32 s33, 2
    s_cselect_b32 s58, s54, 0
    s_waitcnt vmcnt(5)
    v_mfma_f32_16x16x32_bf16 v[240:243], v[104:107], v[72:75], v[240:243]
    v_mfma_f32_16x16x32_bf16 v[240:243], v[108:111], v[76:79], v[240:243]
    global_load_dwordx4 v[112:115], v11, s[6:7] nt
    v_xor_b32 v253, 4096, v11
    global_load_dwordx4 v[116:119], v253, s[6:7] nt
    v_mov_b32 v49, 1
    s_nop 3
    ds_write_b128 v30, v[240:243] offset:0
    ds_add_rtn_u32 v48, v0, v49 offset:21760
    ds_read2st64_b32 v[40:41], v0 offset0:0 offset1:1
    ds_read2st64_b32 v[42:43], v0 offset0:2 offset1:3
    ds_read2st64_b32 v[44:45], v0 offset0:4 offset1:5
    ds_read2st64_b32 v[46:47], v0 offset0:6 offset1:7
    v_add_u32 v50, s46, v0
    s_cmp_eq_u32 s54, 1
    s_waitcnt lgkmcnt(4)
    v_cmp_eq_u32_sdwa vcc, v48, 3 src0_sel:BYTE_0 src1_sel:DWORD
    s_nop 0
    s_cbranch_vccnz L_stqN_l
    global_load_dword v252, v2, s[4:5]
    s_waitcnt lgkmcnt(0)
    s_branch L_stqN_d
L_stqN_l:
    s_mov_b64 exec, vcc
    s_waitcnt lgkmcnt(2)
    v_pk_add_f32 v[40:41], v[40:41], v[42:43]
    s_waitcnt lgkmcnt(0)
    v_pk_add_f32 v[44:45], v[44:45], v[46:47]
    v_pk_add_f32 v[40:41], v[40:41], v[44:45]
    v_add_f32 v40, v40, v41
    v_bfi_b32 v40, v3, v23, v40
    s_cbranch_scc0 L_stqN_s
    global_store_dword v50, v40, s[26:27]
L_stqN_d:
    s_mov_b64 exec, -1
    s_waitcnt vmcnt(5)
    v_xor_b32 v253, 8192, v11
    global_load_dwordx4 v[120:123], v253, s[6:7] nt
    v_xor_b32 v253, 12288, v11
    global_load_dwordx4 v[124:127], v253, s[6:7] nt
    global_load_ushort v38, v19, s[4:5]
    v_mfma_f32_16x16x32_bf16 v[240:243], v[96:99], v[80:83], 0
    v_mfma_f32_16x16x32_bf16 v[240:243], v[100:103], v[84:87], v[240:243]
    s_waitcnt vmcnt(6)
    v_mfma_f32_16x16x32_bf16 v[240:243], v[104:107], v[88:91], v[240:243]
    v_mfma_f32_16x16x32_bf16 v[240:243], v[108:111], v[92:95], v[240:243]
    v_xor_b32 v253, 16384, v11
    global_load_dwordx4 v[128:131], v253, s[6:7] nt
    v_xor_b32 v253, 20480, v11
    global_load_dwordx4 v[132:135], v253, s[6:7] nt
    v_mov_b32 v49, 256
    s_nop 2
    ds_write_b128 v30, v[240:243] offset:4096
    ds_add_rtn_u32 v48, v0, v49 offset:21760
    ds_read2st64_b32 v[40:41], v0 offset0:16 offset1:17
    ds_read2st64_b32 v[42:43], v0 offset0:18 offset1:19
    ds_read2st64_b32 v[44:45], v0 offset0:20 offset1:21
    ds_read2st64_b32 v[46:47], v0 offset0:22 offset1:23
    v_add_u32 v50, s47, v0
    s_cmp_eq_u32 s58, 1
    s_waitcnt lgkmcnt(4)
    v_cmp_eq_u32_sdwa vcc, v48, 3 src0_sel:BYTE_1 src1_sel:DWORD
    s_nop 0
    s_cbranch_vccnz L_stgN_l
    global_load_dword v252, v2, s[4:5]
    s_waitcnt lgkmcnt(0)
    s_branch L_stgN_d
L_stgN_l:
    s_mov_b64 exec, vcc
    s_waitcnt lgkmcnt(2)
    v_pk_add_f32 v[40:41], v[40:41], v[42:43]
    s_waitcnt lgkmcnt(0)
    v_pk_add_f32 v[44:45], v[44:45], v[46:47]
    v_pk_add_f32 v[40:41], v[40:41], v[44:45]
    v_add_f32_e64 v40, v40, v41
    v_bfi_b32 v40, v3, v23, v40
    s_cbranch_scc0 L_stgN_s
    global_store_dword v50, v40, s[26:27]
L_stgN_d:
    s_mov_b64 exec, -1
    v_xor_b32 v253, 24576, v11
    global_load_dwordx4 v[136:139], v253, s[6:7] nt
    v_xor_b32 v253, 28672, v11
    global_load_dwordx4 v[140:143], v253, s[6:7] nt
    global_load_ubyte v255, v254, s[24:25] sc1
    global_load_dwordx4 v[96:99], v14, s[26:27] offset:-4096 sc1
    global_load_dwordx4 v[100:103], v14, s[26:27] offset:0 sc1
    s_barrier
    global_load_dwordx4 v[144:147], v12, s[8:9] nt
    v_xor_b32 v253, 4096, v12
    global_load_dwordx4 v[148:151], v253, s[8:9] nt
    v_lshrrev_b32 v43, 4, v1
    v_bfe_u32 v44, v1, 3, 1
    v_and_b32 v45, 3, v1
    v_bfe_u32 v46, v1, 2, 2
    v_and_b32 v47, 1, v46
    v_and_b32 v49, 0x70, v9
    v_and_b32 v50, 2, v1
    v_lshlrev_b32 v50, 3, v50
    v_mov_b32 v51, 0xffff
    v_lshlrev_b32 v8, v50, v51
    v_lshrrev_b32 v50, 5, v1
    v_lshrrev_b32 v32, 1, v37
    v_lshl_add_u32 v32, v50, 2, v32
    s_lshl_b32 s35, s30, 8
    v_add_u32 v32, s35, v32
    v_lshlrev_b32 v33, 8, v45
    v_lshl_add_u32 v33, v46, 4, v33
    v_lshl_add_u32 v33, v43, 6, v33
    s_lshl_b32 s35, s30, 3
    v_lshl_add_u32 v34, v45, 5, s35
    s_lshl_b32 s35, s30, 5
    v_mov_b32 v35, s35
    s_lshl_b32 s35, s30, 11
    s_addk_i32 s35, 13568
    v_lshl_add_u32 v36, v1, 2, s35
    v_add_u32 v39, s50, v37
    s_lshl_b32 s34, s30, 9
    s_addk_i32 s34, 13568
    v_add_u32 v37, s34, v37
    s_mov_b32 s36, s31
    s_lshl2_add_u32 s32, s28, s36
    s_and_b32 s34, s30, 1
    s_lshr_b32 s35, s30, 1
    s_lshl2_add_u32 s34, s34, s35
    s_lshl_b32 s35, s32, 7
    s_add_u32 s34, s34, s35
    s_lshl3_add_u32 s34, s34, s33
    s_lshl_b32 s34, s34, 7
    v_lshl_add_u32 v26, v43, 13, v49
    v_lshl_add_u32 v26, v44, 11, v26
    v_add_u32 v26, s34, v26
    v_add_u32 v27, 32768, v26
    v_add_u32 v28, 65536, v26
    v_add_u32 v29, 98304, v26
    s_add_u32 s34, s28, s33
    s_and_b32 s34, s34, 1
    s_cmp_eq_u32 s36, 3
    s_cselect_b32 s52, s34, 0
    s_sub_u32 s36, s36, s52
    s_mul_i32 s34, s28, 3
    s_add_u32 s34, s34, s36
    s_lshr_b32 s35, s28, 1
    s_add_u32 s35, s35, 24
    s_cmp_eq_u32 s36, 3
    s_cselect_b32 s34, s35, s34
    s_lshl2_add_u32 s36, s34, s30
    s_lshl_b32 s36, s36, 7
    s_add_u32 s36, s36, s33
    s_lshl_b32 s36, s36, 7
    s_addk_i32 s36, 4096
    v_lshl_add_u32 v13, v43, 10, v49
    v_lshl_add_u32 v13, v44, 13, v13
    v_add_u32 v13, s36, v13
    s_lshl_b32 s34, s34, 11
    s_add_u32 s34, s34, s37
    s_add_u32 s34, s34, 73728
    v_lshlrev_b32 v51, 5, v44
    v_xor_b32 v15, v51, v2
    v_lshl_add_u32 v15, v43, 8, v15
    v_lshl_add_u32 v15, v47, 10, v15
    v_add_u32 v15, s34, v15
    v_lshl_add_u32 v51, v43, 1, v47
    s_lshl_b32 s34, s32, 9
    s_add_u32 s34, s34, 131072
    v_lshl_add_u32 v16, v51, 6, v2
    v_add_u32 v16, s34, v16
    v_mul_u32_u24 v50, 48, v47
    v_xor_b32 v17, v50, v2
    v_lshl_add_u32 v17, v44, 6, v17
    v_lshl_add_u32 v17, v51, 11, v17
    s_lshl_b32 s34, s32, 7
    s_add_u32 s34, s34, s30
    s_lshl_b32 s34, s34, 7
    s_add_u32 s34, s34, 262144
    v_add_u32 v17, s34, v17
    s_lshl_b32 s34, s33, 5
    s_add_u32 s34, s34, s32
    s_lshl_b32 s34, s34, 8
    s_add_u32 s34, s34, 163840
    v_add_u32 v21, s34, v0
    s_mov_b32 s14, 0
    s_mov_b32 s15, 0x42700000
    s_mov_b32 s56, 0
    s_mov_b32 s57, 0x3d700000
    v_mov_b64 v[176:177], 0
    v_mov_b64 v[178:179], 0
    v_mov_b64 v[180:181], 0
    v_mov_b64 v[182:183], 0
    v_mov_b64 v[184:185], 0
    v_mov_b64 v[186:187], 0
    v_mov_b64 v[188:189], 0
    v_mov_b64 v[190:191], 0
    v_mov_b64 v[192:193], 0
    v_mov_b64 v[194:195], 0
    v_mov_b64 v[196:197], 0
    v_mov_b64 v[198:199], 0
    v_mov_b64 v[200:201], 0
    v_mov_b64 v[202:203], 0
    v_mov_b64 v[204:205], 0
    v_mov_b64 v[206:207], 0
    v_mov_b64 v[208:209], 0
    v_mov_b64 v[210:211], 0
    v_mov_b64 v[212:213], 0
    v_mov_b64 v[214:215], 0
    v_mov_b64 v[216:217], 0
    v_mov_b64 v[218:219], 0
    v_mov_b64 v[220:221], 0
    v_mov_b64 v[222:223], 0
    v_mov_b64 v[224:225], 0
    v_mov_b64 v[226:227], 0
    v_mov_b64 v[228:229], 0
    v_mov_b64 v[230:231], 0
    v_mov_b64 v[232:233], 0
    v_mov_b64 v[234:235], 0
    v_mov_b64 v[236:237], 0
    v_mov_b64 v[238:239], 0
    s_waitcnt vmcnt(11)
    global_load_dwordx4 v[104:107], v14, s[26:27] offset:-4096 sc1
    global_load_dwordx4 v[108:111], v14, s[26:27] offset:0 sc1
    v_xor_b32 v253, 8192, v12
    global_load_dwordx4 v[152:155], v253, s[8:9] nt
    v_xor_b32 v253, 12288, v12
    global_load_dwordx4 v[156:159], v253, s[8:9] nt
    s_waitcnt vmcnt(12)
    v_xor_b32 v253, 16384, v12
    global_load_dwordx4 v[160:163], v253, s[8:9] nt
    v_xor_b32 v253, 20480, v12
    global_load_dwordx4 v[164:167], v253, s[8:9] nt
    s_waitcnt vmcnt(8)
L_qN_chk:
    v_xor_b32 v96, s40, v96
    v_xor_b32 v97, s41, v97
    v_xor_b32 v98, s42, v98
    v_xor_b32 v99, s43, v99
    v_xor_b32 v100, s40, v100
    v_xor_b32 v101, s41, v101
    v_xor_b32 v102, s42, v102
    v_xor_b32 v103, s43, v103
    v_or3_b32 v40, v96, v97, v98
    v_or3_b32 v40, v40, v99, v100
    v_or3_b32 v40, v40, v101, v102
    v_bitop3_b32 v40, v40, v103, v3 bitop3:0xa8
    v_cmp_ne_u32 vcc, 0, v40
    s_nop 0
    s_cbranch_vccnz L_qN_re
L_qN_ok:
    s_mov_b64 exec, -1
    v_pk_add_f32 v[96:97], v[96:97], v[100:101]
    v_pk_add_f32 v[98:99], v[98:99], v[102:103]
    v_cmp_ne_u32 vcc, s53, v255
    s_nop 0
    v_permlane32_swap_b32 v96, v98
    v_permlane32_swap_b32 v97, v99
    v_pk_add_f32 v[96:97], v[96:97], v[98:99]
    v_cvt_pk_bf16_f32 v96, v96, v97
    ds_write_b32 v32, v96 offset:12288
    s_cmp_eq_u64 vcc, 0
    s_cselect_b32 s54, 1, 0
    s_waitcnt lgkmcnt(0)
    s_barrier
    ds_read_b128 v[100:103], v33 offset:12288
    v_xor_b32 v253, 24576, v12
    global_load_dwordx4 v[168:171], v253, s[8:9] nt
    v_xor_b32 v253, 28672, v12
    global_load_dwordx4 v[172:175], v253, s[8:9] nt
    global_load_dwordx4 v[88:91], v15, s[26:27] sc1
    global_load_dwordx4 v[92:95], v22, s[26:27] sc1
    s_waitcnt lgkmcnt(0)
    v_mfma_f32_16x16x32_bf16 v[240:243], v[112:115], v[100:103], 0
    v_mfma_f32_16x16x32_bf16 v[112:115], v[116:119], v[100:103], 0
    v_mfma_f32_16x16x32_bf16 v[116:119], v[120:123], v[100:103], 0
    v_mfma_f32_16x16x32_bf16 v[120:123], v[124:127], v[100:103], 0
    v_mfma_f32_16x16x32_bf16 v[124:127], v[128:131], v[100:103], 0
    v_mfma_f32_16x16x32_bf16 v[128:131], v[132:135], v[100:103], 0
    v_mfma_f32_16x16x32_bf16 v[132:135], v[136:139], v[100:103], 0
    v_mfma_f32_16x16x32_bf16 v[136:139], v[140:143], v[100:103], 0
    s_nop 0
    v_add_f32_dpp v40, v241, v240 row_ror:12 row_mask:0xf bank_mask:0x1
    v_add_f32_dpp v40, v242, v40 row_ror:8 row_mask:0xf bank_mask:0x1
    v_add_f32_dpp v40, v243, v40 row_ror:4 row_mask:0xf bank_mask:0x1
    v_add_f32_dpp v40, v112, v113 row_ror:4 row_mask:0xf bank_mask:0x2
    v_add_f32_dpp v40, v114, v40 row_ror:12 row_mask:0xf bank_mask:0x2
    v_add_f32_dpp v40, v115, v40 row_ror:8 row_mask:0xf bank_mask:0x2
    v_add_f32_dpp v40, v116, v118 row_ror:8 row_mask:0xf bank_mask:0x4
    v_add_f32_dpp v40, v117, v40 row_ror:4 row_mask:0xf bank_mask:0x4
    v_add_f32_dpp v40, v119, v40 row_ror:12 row_mask:0xf bank_mask:0x4
    v_add_f32_dpp v40, v120, v123 row_ror:12 row_mask:0xf bank_mask:0x8
    v_add_f32_dpp v40, v121, v40 row_ror:8 row_mask:0xf bank_mask:0x8
    v_add_f32_dpp v40, v122, v40 row_ror:4 row_mask:0xf bank_mask:0x8
    v_add_f32_dpp v41, v125, v124 row_ror:12 row_mask:0xf bank_mask:0x1
    v_add_f32_dpp v41, v126, v41 row_ror:8 row_mask:0xf bank_mask:0x1
    v_add_f32_dpp v41, v127, v41 row_ror:4 row_mask:0xf bank_mask:0x1
    v_add_f32_dpp v41, v128, v129 row_ror:4 row_mask:0xf bank_mask:0x2
    v_add_f32_dpp v41, v130, v41 row_ror:12 row_mask:0xf bank_mask:0x2
    v_add_f32_dpp v41, v131, v41 row_ror:8 row_mask:0xf bank_mask:0x2
    v_add_f32_dpp v41, v132, v134 row_ror:8 row_mask:0xf bank_mask:0x4
    v_add_f32_dpp v41, v133, v41 row_ror:4 row_mask:0xf bank_mask:0x4
    v_add_f32_dpp v41, v135, v41 row_ror:12 row_mask:0xf bank_mask:0x4
    v_add_f32_dpp v41, v136, v139 row_ror:12 row_mask:0xf bank_mask:0x8
    v_add_f32_dpp v41, v137, v41 row_ror:8 row_mask:0xf bank_mask:0x8
    v_add_f32_dpp v41, v138, v41 row_ror:4 row_mask:0xf bank_mask:0x8
    v_cvt_pk_bf16_f32 v40, 0, v40
    v_cvt_pk_bf16_f32 v41, 0, v41
    v_mul_f32 v40, 0x3db504f3, v40
    v_mul_f32 v41, 0x3db504f3, v41
    v_cvt_pk_bf16_f32 v40, 0, v40
    v_cvt_pk_bf16_f32 v41, 0, v41
    v_max_f32 v44, v40, v41
    s_nop 1
    v_max_f32_dpp v44, v44, v44 row_ror:4 row_mask:0xf bank_mask:0xf
    s_nop 1
    v_max_f32_dpp v44, v44, v44 row_ror:8 row_mask:0xf bank_mask:0xf
    v_mov_b32 v43, v44
    s_nop 1
    v_permlane16_swap_b32 v43, v44
    v_max_f32 v44, v43, v44
    v_mov_b32 v43, v44
    s_nop 1
    v_permlane32_swap_b32 v43, v44
    v_max_f32 v44, v43, v44
    v_sub_f32 v40, v40, v44
    v_sub_f32 v41, v41, v44
    v_mul_f32 v40, 0x3fb8aa3b, v40
    v_mul_f32 v41, 0x3fb8aa3b, v41
    v_exp_f32 v40, v40
    v_exp_f32 v41, v41
    s_nop 0
    v_add_f32_e64 v45, v40, v41
    v_cvt_pk_bf16_f32 v40, v40, v40
    v_cvt_pk_bf16_f32 v41, v41, v41
    v_add_f32_dpp v45, v45, v45 row_ror:4 row_mask:0xf bank_mask:0xf
    v_and_b32_dpp v60, v40, v8 quad_perm:[0,1,0,1] row_mask:0xf bank_mask:0xf
    v_and_b32_dpp v61, v40, v8 quad_perm:[2,3,2,3] row_mask:0xf bank_mask:0xf
    v_and_b32_dpp v62, v41, v8 quad_perm:[0,1,0,1] row_mask:0xf bank_mask:0xf
    v_and_b32_dpp v63, v41, v8 quad_perm:[2,3,2,3] row_mask:0xf bank_mask:0xf
    v_add_f32_dpp v45, v45, v45 row_ror:8 row_mask:0xf bank_mask:0xf
    v_mov_b32 v43, v45
    v_mov_b32_dpp v176, v60 quad_perm:[0,1,2,3] row_mask:0xf bank_mask:0x1
    v_mov_b32_dpp v177, v60 row_ror:4 row_mask:0xf bank_mask:0x2
    v_permlane16_swap_b32 v43, v45
    v_add_f32 v45, v43, v45
    v_mov_b32 v43, v45
    v_mov_b32_dpp v178, v60 row_ror:8 row_mask:0xf bank_mask:0x4
    v_mov_b32_dpp v179, v60 row_ror:12 row_mask:0xf bank_mask:0x8
    v_permlane32_swap_b32 v43, v45
    v_add_f32 v45, v43, v45
    ds_write_b64 v34, v[44:45] offset:13312
    v_mov_b32_dpp v180, v61 quad_perm:[0,1,2,3] row_mask:0xf bank_mask:0x1
    v_mov_b32_dpp v181, v61 row_ror:4 row_mask:0xf bank_mask:0x2
    v_mov_b32_dpp v182, v61 row_ror:8 row_mask:0xf bank_mask:0x4
    v_mov_b32_dpp v183, v61 row_ror:12 row_mask:0xf bank_mask:0x8
    v_mov_b32_dpp v184, v60 row_ror:12 row_mask:0xf bank_mask:0x1
    v_mov_b32_dpp v185, v60 quad_perm:[0,1,2,3] row_mask:0xf bank_mask:0x2
    v_mov_b32_dpp v186, v60 row_ror:4 row_mask:0xf bank_mask:0x4
    v_mov_b32_dpp v187, v60 row_ror:8 row_mask:0xf bank_mask:0x8
    v_mov_b32_dpp v188, v61 row_ror:12 row_mask:0xf bank_mask:0x1
    v_mov_b32_dpp v189, v61 quad_perm:[0,1,2,3] row_mask:0xf bank_mask:0x2
    v_mov_b32_dpp v190, v61 row_ror:4 row_mask:0xf bank_mask:0x4
    v_mov_b32_dpp v191, v61 row_ror:8 row_mask:0xf bank_mask:0x8
    v_mov_b32_dpp v192, v60 row_ror:8 row_mask:0xf bank_mask:0x1
    v_mov_b32_dpp v193, v60 row_ror:12 row_mask:0xf bank_mask:0x2
    v_mov_b32_dpp v194, v60 quad_perm:[0,1,2,3] row_mask:0xf bank_mask:0x4
    v_mov_b32_dpp v195, v60 row_ror:4 row_mask:0xf bank_mask:0x8
    s_waitcnt lgkmcnt(0)
    s_barrier
    ds_read_b128 v[128:131], v35 offset:13312
    ds_read_b128 v[132:135], v35 offset:13328
    v_mov_b32 v58, s42
    v_mov_b32 v59, s43
    v_mov_b32 v55, s49
    s_cmp_eq_u32 s54, 1
    v_mov_b32_dpp v196, v61 row_ror:8 row_mask:0xf bank_mask:0x1
    v_mov_b32_dpp v197, v61 row_ror:12 row_mask:0xf bank_mask:0x2
    v_mov_b32_dpp v198, v61 quad_perm:[0,1,2,3] row_mask:0xf bank_mask:0x4
    v_mov_b32_dpp v199, v61 row_ror:4 row_mask:0xf bank_mask:0x8
    v_mov_b32_dpp v200, v60 row_ror:4 row_mask:0xf bank_mask:0x1
    v_mov_b32_dpp v201, v60 row_ror:8 row_mask:0xf bank_mask:0x2
    v_mov_b32_dpp v202, v60 row_ror:12 row_mask:0xf bank_mask:0x4
    v_mov_b32_dpp v203, v60 quad_perm:[0,1,2,3] row_mask:0xf bank_mask:0x8
    v_mov_b32_dpp v204, v61 row_ror:4 row_mask:0xf bank_mask:0x1
    v_mov_b32_dpp v205, v61 row_ror:8 row_mask:0xf bank_mask:0x2
    v_mov_b32_dpp v206, v61 row_ror:12 row_mask:0xf bank_mask:0x4
    v_mov_b32_dpp v207, v61 quad_perm:[0,1,2,3] row_mask:0xf bank_mask:0x8
    s_waitcnt lgkmcnt(0)
    v_max3_f32 v56, v128, v130, v132
    v_max_f32 v56, v56, v134
    v_sub_f32 v128, v128, v56
    v_sub_f32 v130, v130, v56
    v_sub_f32 v132, v132, v56
    v_sub_f32 v134, v134, v56
    v_mul_f32 v128, 0x3fb8aa3b, v128
    v_mul_f32 v130, 0x3fb8aa3b, v130
    v_mul_f32 v132, 0x3fb8aa3b, v132
    v_mul_f32 v134, 0x3fb8aa3b, v134
    v_exp_f32 v128, v128
    v_exp_f32 v130, v130
    v_exp_f32 v132, v132
    v_exp_f32 v134, v134
    v_mul_f32 v57, v128, v129
    v_fmac_f32 v57, v130, v131
    v_fmac_f32 v57, v132, v133
    v_fmac_f32 v57, v134, v135
    s_mov_b64 exec, 1
    v_bfi_b32 v56, v3, s40, v56
    v_bfi_b32 v57, v3, s41, v57
    s_cbranch_scc0 L_stsN_s
    global_store_dwordx4 v55, v[56:59], s[26:27]
L_stsN_d:
    s_mov_b64 exec, -1
    s_cmp_eq_u32 s52, 1
    s_cbranch_scc1 L_dn_iN
    global_load_dwordx4 v[80:83], v13, s[20:21] offset:-4096 nt
    global_load_dwordx4 v[84:87], v13, s[20:21] offset:0 nt
L_dn_dN:
    s_waitcnt vmcnt(9)
    global_load_dwordx4 v[64:67], v26, s[12:13] nt
    global_load_dwordx4 v[68:71], v27, s[12:13] nt
    v_mfma_f32_16x16x32_bf16 v[240:243], v[176:179], v[144:147], 0
    v_mov_b32_dpp v208, v62 quad_perm:[0,1,2,3] row_mask:0xf bank_mask:0x1
    v_mov_b32_dpp v209, v62 row_ror:4 row_mask:0xf bank_mask:0x2
    v_mov_b32_dpp v210, v62 row_ror:8 row_mask:0xf bank_mask:0x4
    v_mov_b32_dpp v211, v62 row_ror:12 row_mask:0xf bank_mask:0x8
    v_mfma_f32_16x16x32_bf16 v[244:247], v[180:183], v[144:147], 0
    v_mov_b32_dpp v212, v63 quad_perm:[0,1,2,3] row_mask:0xf bank_mask:0x1
    v_mov_b32_dpp v213, v63 row_ror:4 row_mask:0xf bank_mask:0x2
    v_mov_b32_dpp v214, v63 row_ror:8 row_mask:0xf bank_mask:0x4
    v_mov_b32_dpp v215, v63 row_ror:12 row_mask:0xf bank_mask:0x8
    v_mfma_f32_16x16x32_bf16 v[240:243], v[184:187], v[148:151], v[240:243]
    v_mov_b32_dpp v216, v62 row_ror:12 row_mask:0xf bank_mask:0x1
    v_mov_b32_dpp v217, v62 quad_perm:[0,1,2,3] row_mask:0xf bank_mask:0x2
    v_mov_b32_dpp v218, v62 row_ror:4 row_mask:0xf bank_mask:0x4
    v_mov_b32_dpp v219, v62 row_ror:8 row_mask:0xf bank_mask:0x8
    v_mfma_f32_16x16x32_bf16 v[244:247], v[188:191], v[148:151], v[244:247]
    v_mov_b32_dpp v220, v63 row_ror:12 row_mask:0xf bank_mask:0x1
    v_mov_b32_dpp v221, v63 quad_perm:[0,1,2,3] row_mask:0xf bank_mask:0x2
    v_mov_b32_dpp v222, v63 row_ror:4 row_mask:0xf bank_mask:0x4
    v_mov_b32_dpp v223, v63 row_ror:8 row_mask:0xf bank_mask:0x8
    v_mfma_f32_16x16x32_bf16 v[240:243], v[192:195], v[152:155], v[240:243]
    v_mov_b32_dpp v224, v62 row_ror:8 row_mask:0xf bank_mask:0x1
    v_mov_b32_dpp v225, v62 row_ror:12 row_mask:0xf bank_mask:0x2
    v_mov_b32_dpp v226, v62 quad_perm:[0,1,2,3] row_mask:0xf bank_mask:0x4
    v_mov_b32_dpp v227, v62 row_ror:4 row_mask:0xf bank_mask:0x8
    v_mfma_f32_16x16x32_bf16 v[244:247], v[196:199], v[152:155], v[244:247]
    v_mov_b32_dpp v228, v63 row_ror:8 row_mask:0xf bank_mask:0x1
    v_mov_b32_dpp v229, v63 row_ror:12 row_mask:0xf bank_mask:0x2
    v_mov_b32_dpp v230, v63 quad_perm:[0,1,2,3] row_mask:0xf bank_mask:0x4
    v_mov_b32_dpp v231, v63 row_ror:4 row_mask:0xf bank_mask:0x8
    v_mfma_f32_16x16x32_bf16 v[240:243], v[200:203], v[156:159], v[240:243]
    v_mov_b32_dpp v232, v62 row_ror:4 row_mask:0xf bank_mask:0x1
    v_mov_b32_dpp v233, v62 row_ror:8 row_mask:0xf bank_mask:0x2
    v_mov_b32_dpp v234, v62 row_ror:12 row_mask:0xf bank_mask:0x4
    v_mov_b32_dpp v235, v62 quad_perm:[0,1,2,3] row_mask:0xf bank_mask:0x8
    v_mfma_f32_16x16x32_bf16 v[244:247], v[204:207], v[156:159], v[244:247]
    v_mov_b32_dpp v236, v63 row_ror:4 row_mask:0xf bank_mask:0x1
    v_mov_b32_dpp v237, v63 row_ror:8 row_mask:0xf bank_mask:0x2
    v_mov_b32_dpp v238, v63 row_ror:12 row_mask:0xf bank_mask:0x4
    v_mov_b32_dpp v239, v63 quad_perm:[0,1,2,3] row_mask:0xf bank_mask:0x8
    s_waitcnt vmcnt(9)
    global_load_dwordx4 v[72:75], v28, s[12:13] nt
    global_load_dwordx4 v[76:79], v29, s[12:13] nt
    v_mfma_f32_16x16x32_bf16 v[240:243], v[208:211], v[160:163], v[240:243]
    v_mfma_f32_16x16x32_bf16 v[244:247], v[212:215], v[160:163], v[244:247]
    v_mfma_f32_16x16x32_bf16 v[240:243], v[216:219], v[164:167], v[240:243]
    v_mfma_f32_16x16x32_bf16 v[244:247], v[220:223], v[164:167], v[244:247]
    s_waitcnt vmcnt(10)
    v_mfma_f32_16x16x32_bf16 v[240:243], v[224:227], v[168:171], v[240:243]
    v_mfma_f32_16x16x32_bf16 v[244:247], v[228:231], v[168:171], v[244:247]
    s_waitcnt vmcnt(9)
    v_mfma_f32_16x16x32_bf16 v[240:243], v[232:235], v[172:175], v[240:243]
    v_mfma_f32_16x16x32_bf16 v[244:247], v[236:239], v[172:175], v[244:247]
    s_nop 6
    ds_write2st64_b32 v36, v240, v242 offset0:0 offset1:1
    ds_write2st64_b32 v36, v241, v243 offset0:2 offset1:3
    ds_write2st64_b32 v36, v244, v246 offset0:4 offset1:5
    ds_write2st64_b32 v36, v245, v247 offset0:6 offset1:7
    s_waitcnt lgkmcnt(0)
    s_barrier
    ds_read_b128 v[40:43], v37 offset:0
    ds_read_b128 v[44:47], v37 offset:2048
    ds_read_b128 v[48:51], v37 offset:4096
    ds_read_b128 v[52:55], v37 offset:6144
    s_mov_b32 exec_hi, 0
    s_cmp_eq_u32 s54, 1
    s_waitcnt lgkmcnt(3)
    v_pk_mul_f32 v[40:41], v[128:129], v[40:41] op_sel_hi:[0,1]
    v_pk_mul_f32 v[42:43], v[128:129], v[42:43] op_sel_hi:[0,1]
    s_waitcnt lgkmcnt(2)
    v_pk_fma_f32 v[40:41], v[130:131], v[44:45], v[40:41] op_sel_hi:[0,1,1]
    v_pk_fma_f32 v[42:43], v[130:131], v[46:47], v[42:43] op_sel_hi:[0,1,1]
    s_waitcnt lgkmcnt(1)
    v_pk_fma_f32 v[40:41], v[132:133], v[48:49], v[40:41] op_sel_hi:[0,1,1]
    v_pk_fma_f32 v[42:43], v[132:133], v[50:51], v[42:43] op_sel_hi:[0,1,1]
    s_waitcnt lgkmcnt(0)
    v_pk_fma_f32 v[40:41], v[134:135], v[52:53], v[40:41] op_sel_hi:[0,1,1]
    v_pk_fma_f32 v[42:43], v[134:135], v[54:55], v[42:43] op_sel_hi:[0,1,1]
    v_bfi_b32 v40, v3, s40, v40
    v_bfi_b32 v41, v3, s41, v41
    v_bfi_b32 v42, v3, s42, v42
    v_bfi_b32 v43, v3, s43, v43
    s_cbranch_scc0 L_stoN_s
    global_store_dwordx4 v39, v[40:43], s[26:27]
L_stoN_d:
    s_mov_b32 exec_hi, -1
    global_load_dwordx4 v[248:251], v16, s[26:27] sc1
    s_waitcnt vmcnt(9)
L_gN_chk:
    v_xor_b32 v88, s40, v88
    v_xor_b32 v89, s41, v89
    v_xor_b32 v90, s42, v90
    v_xor_b32 v91, s43, v91
    v_xor_b32 v92, s40, v92
    v_xor_b32 v93, s41, v93
    v_xor_b32 v94, s42, v94
    v_xor_b32 v95, s43, v95
    v_or3_b32 v44, v88, v89, v90
    v_or3_b32 v44, v44, v91, v92
    v_or3_b32 v44, v44, v93, v94
    v_bitop3_b32 v44, v44, v95, v3 bitop3:0xa8
    v_cmp_ne_u32 vcc, 0, v44
    s_nop 0
    s_cbranch_vccnz L_gN_re
L_gN_ok:
    s_mov_b64 exec, -1
    v_permlane32_swap_b32 v88, v90
    v_permlane32_swap_b32 v89, v91
    v_add_f32 v88, v88, v90
    v_add_f32 v89, v89, v91
    s_nop 1
    v_permlane16_swap_b32 v88, v89
    v_add_f32 v88, v88, v89
    v_cvt_pk_bf16_f32 v44, 0, v88
    v_mul_f32 v46, v44, v44
    v_mul_f32 v46, 0x3d372713, v46
    v_fma_f32 v46, v46, v44, v44
    v_mul_f32 v46, 0xc0135761, v46
    v_exp_f32 v46, v46
    v_mov_b64 v[240:241], 0
    v_add_f32 v46, 1.0, v46
    v_rcp_f32 v46, v46
    v_mov_b64 v[242:243], 0
    v_mul_f32_e64 v46, v46, v44
    v_cvt_pk_bf16_f32 v46, 0, v46
    v_mul_f32_dpp v45, v44, v46 row_shl:4 row_mask:0xf bank_mask:0x5
    s_nop 0
    v_mul_f32_dpp v45, v46, v44 row_shr:4 row_mask:0xf bank_mask:0xa
    v_cvt_pk_bf16_f32 v46, v45, v45
    s_nop 1
    v_and_b32_dpp v96, v46, v4 quad_perm:[0,0,0,0] row_mask:0xf bank_mask:0xf
    v_and_b32_dpp v97, v46, v5 quad_perm:[0,0,0,0] row_mask:0xf bank_mask:0xf
    v_and_b32_dpp v98, v46, v6 quad_perm:[0,0,0,0] row_mask:0xf bank_mask:0xf
    v_and_b32_dpp v99, v46, v7 quad_perm:[0,0,0,0] row_mask:0xf bank_mask:0xf
    v_and_b32_dpp v100, v46, v4 quad_perm:[1,1,1,1] row_mask:0xf bank_mask:0xf
    v_and_b32_dpp v101, v46, v5 quad_perm:[1,1,1,1] row_mask:0xf bank_mask:0xf
    v_and_b32_dpp v102, v46, v6 quad_perm:[1,1,1,1] row_mask:0xf bank_mask:0xf
    v_and_b32_dpp v103, v46, v7 quad_perm:[1,1,1,1] row_mask:0xf bank_mask:0xf
    v_mov_b32 v58, 0
    v_mov_b32 v59, 0x43304000
    v_mov_b32 v60, 0
    v_mov_b32 v61, 0xc0b80000
    v_lshlrev_b32 v38, 16, v38
    s_cmp_eq_u32 s52, 1
L_tail:
    s_waitcnt vmcnt(0)
    global_load_dwordx4 v[136:139], v16, s[26:27] sc1
    global_load_dwordx4 v[112:115], v17, s[26:27] offset:0 sc1
    s_cbranch_scc1 L_nodown
    v_mfma_f32_16x16x32_bf16 v[240:243], v[96:99], v[80:83], v[240:243]
    v_mfma_f32_16x16x32_bf16 v[240:243], v[100:103], v[84:87], v[240:243]
L_nodown:
L_s_chk:
    v_xor_b32 v248, s40, v248
    v_xor_b32 v249, s41, v249
    v_xor_b32 v250, s42, v250
    v_xor_b32 v251, s43, v251
    v_or3_b32 v40, v248, v249, v250
    v_bitop3_b32 v40, v40, v251, v3 bitop3:0xa8
    v_cmp_ne_u32 vcc, 0, v40
    s_nop 0
    s_cbranch_vccnz L_s_re
L_s_ok:
    s_mov_b64 exec, -1
    global_load_dwordx4 v[116:119], v17, s[26:27] offset:512 sc1
    v_max_f32_dpp v40, v248, v248 quad_perm:[1,0,3,2] row_mask:0xf bank_mask:0xf
    s_nop 1
    v_max_f32_dpp v40, v40, v40 quad_perm:[2,3,0,1] row_mask:0xf bank_mask:0xf
    s_nop 1
    v_max_f32_dpp v40, v40, v40 row_half_mirror row_mask:0xf bank_mask:0xf
    v_mov_b32 v41, v40
    s_nop 1
    v_permlane16_swap_b32 v41, v40
    v_max_f32 v40, v41, v40
    global_load_dwordx4 v[120:123], v17, s[26:27] offset:1024 sc1
    v_mov_b32 v41, v40
    s_nop 1
    v_permlane32_swap_b32 v41, v40
    v_max_f32 v40, v41, v40
    v_sub_f32 v40, v248, v40
    v_mul_f32 v40, 0x3fb8aa3b, v40
    v_exp_f32 v40, v40
    global_load_dwordx4 v[124:127], v17, s[26:27] offset:1536 sc1
    v_mul_f32 v42, v40, v249
    s_nop 1
    v_add_f32_dpp v42, v42, v42 quad_perm:[1,0,3,2] row_mask:0xf bank_mask:0xf
    s_nop 1
    v_add_f32_dpp v42, v42, v42 quad_perm:[2,3,0,1] row_mask:0xf bank_mask:0xf
    s_nop 1
    v_add_f32_dpp v42, v42, v42 row_half_mirror row_mask:0xf bank_mask:0xf
    v_mov_b32 v41, v42
    s_nop 1
    v_permlane16_swap_b32 v41, v42
    v_add_f32 v42, v41, v42
    v_mov_b32 v41, v42
    s_nop 1
    v_permlane32_swap_b32 v41, v42
    v_add_f32 v42, v41, v42
    v_rcp_f32 v42, v42
    s_nop 0
    v_mul_f32_dpp v48, v40, v42 quad_perm:[0,0,0,0] row_mask:0xf bank_mask:0xf
    v_mul_f32_dpp v50, v40, v42 quad_perm:[1,1,1,1] row_mask:0xf bank_mask:0xf
    v_mul_f32_dpp v52, v40, v42 quad_perm:[2,2,2,2] row_mask:0xf bank_mask:0xf
    v_mul_f32_dpp v54, v40, v42 quad_perm:[3,3,3,3] row_mask:0xf bank_mask:0xf
L_o_chk:
    s_waitcnt vmcnt(3)
    v_xor_b32 v112, s40, v112
    v_xor_b32 v113, s41, v113
    v_xor_b32 v114, s42, v114
    v_xor_b32 v115, s43, v115
    v_or3_b32 v41, v112, v113, v114
    v_pk_mul_f32 v[44:45], v[48:49], v[112:113] op_sel_hi:[0,1]
    v_pk_mul_f32 v[46:47], v[48:49], v[114:115] op_sel_hi:[0,1]
    s_waitcnt vmcnt(2)
    v_xor_b32 v116, s40, v116
    v_xor_b32 v117, s41, v117
    v_xor_b32 v118, s42, v118
    v_xor_b32 v119, s43, v119
    v_or3_b32 v41, v41, v115, v116
    v_or3_b32 v41, v41, v117, v118
    v_pk_fma_f32 v[44:45], v[50:51], v[116:117], v[44:45] op_sel_hi:[0,1,1]
    v_pk_fma_f32 v[46:47], v[50:51], v[118:119], v[46:47] op_sel_hi:[0,1,1]
    s_waitcnt vmcnt(1)
    v_xor_b32 v120, s40, v120
    v_xor_b32 v121, s41, v121
    v_xor_b32 v122, s42, v122
    v_xor_b32 v123, s43, v123
    v_or3_b32 v41, v41, v119, v120
    v_or3_b32 v41, v41, v121, v122
    v_pk_fma_f32 v[44:45], v[52:53], v[120:121], v[44:45] op_sel_hi:[0,1,1]
    v_pk_fma_f32 v[46:47], v[52:53], v[122:123], v[46:47] op_sel_hi:[0,1,1]
    s_waitcnt vmcnt(0)
    v_xor_b32 v124, s40, v124
    v_xor_b32 v125, s41, v125
    v_xor_b32 v126, s42, v126
    v_xor_b32 v127, s43, v127
    v_or3_b32 v41, v41, v123, v124
    v_or3_b32 v41, v41, v125, v126
    v_bitop3_b32 v41, v41, v127, v3 bitop3:0xa8
    v_cmp_ne_u32 vcc, 0, v41
    v_pk_fma_f32 v[44:45], v[54:55], v[124:125], v[44:45] op_sel_hi:[0,1,1]
    v_pk_fma_f32 v[46:47], v[54:55], v[126:127], v[46:47] op_sel_hi:[0,1,1]
    s_cbranch_vccnz L_o_re
L_o_ok:
    s_mov_b64 exec, -1
    v_permlane32_swap_b32 v44, v46
    v_permlane32_swap_b32 v45, v47
    v_add_f32 v44, v44, v46
    v_add_f32 v45, v45, v47
    s_nop 1
    v_permlane16_swap_b32 v44, v45
    v_add_f32 v44, v44, v45
    s_nop 1
    v_add_f32_dpp v44, v44, v44 row_half_mirror row_mask:0xf bank_mask:0xf
    v_cvt_pk_bf16_f32 v44, v44, v44
    s_nop 1
    v_and_b32_dpp v96, v44, v4 quad_perm:[0,0,0,0] row_mask:0xf bank_mask:0xf
    v_and_b32_dpp v97, v44, v5 quad_perm:[0,0,0,0] row_mask:0xf bank_mask:0xf
    v_and_b32_dpp v98, v44, v6 quad_perm:[3,3,3,3] row_mask:0xf bank_mask:0xf
    v_and_b32_dpp v99, v44, v7 quad_perm:[3,3,3,3] row_mask:0xf bank_mask:0xf
    v_and_b32_dpp v100, v44, v4 quad_perm:[1,1,1,1] row_mask:0xf bank_mask:0xf
    v_and_b32_dpp v101, v44, v5 quad_perm:[1,1,1,1] row_mask:0xf bank_mask:0xf
    v_and_b32_dpp v102, v44, v6 quad_perm:[2,2,2,2] row_mask:0xf bank_mask:0xf
    v_and_b32_dpp v103, v44, v7 quad_perm:[2,2,2,2] row_mask:0xf bank_mask:0xf
    v_mfma_f32_16x16x32_bf16 v[240:243], v[96:99], v[64:67], v[240:243]
    v_and_b32_dpp v104, v44, v4 quad_perm:[2,2,2,2] row_mask:0xf bank_mask:0xf
    v_and_b32_dpp v105, v44, v5 quad_perm:[2,2,2,2] row_mask:0xf bank_mask:0xf
    v_and_b32_dpp v106, v44, v6 quad_perm:[1,1,1,1] row_mask:0xf bank_mask:0xf
    v_and_b32_dpp v107, v44, v7 quad_perm:[1,1,1,1] row_mask:0xf bank_mask:0xf
    v_mfma_f32_16x16x32_bf16 v[240:243], v[100:103], v[68:71], v[240:243]
    v_and_b32_dpp v108, v44, v4 quad_perm:[3,3,3,3] row_mask:0xf bank_mask:0xf
    v_and_b32_dpp v109, v44, v5 quad_perm:[3,3,3,3] row_mask:0xf bank_mask:0xf
    v_and_b32_dpp v110, v44, v6 quad_perm:[0,0,0,0] row_mask:0xf bank_mask:0xf
    v_and_b32_dpp v111, v44, v7 quad_perm:[0,0,0,0] row_mask:0xf bank_mask:0xf
    v_mfma_f32_16x16x32_bf16 v[240:243], v[104:107], v[72:75], v[240:243]
    s_nop 0
    v_mfma_f32_16x16x32_bf16 v[240:243], v[108:111], v[76:79], v[240:243]
    v_mov_b32 v52, 0x04100000
    s_mov_b32 s34, 0x42800000
    v_mov_b32 v49, 65536
    s_nop 4
    ds_write_b128 v30, v[240:243] offset:8192
    ds_add_rtn_u32 v48, v0, v49 offset:21760
    ds_read2st64_b32 v[40:41], v0 offset0:32 offset1:33
    ds_read2st64_b32 v[42:43], v0 offset0:34 offset1:35
    ds_read2st64_b32 v[44:45], v0 offset0:36 offset1:37
    ds_read2st64_b32 v[46:47], v0 offset0:38 offset1:39
    s_waitcnt lgkmcnt(4)
    v_cmp_eq_u32_sdwa vcc, v48, 3 src0_sel:BYTE_2 src1_sel:DWORD
    s_nop 0
    s_mov_b64 exec, vcc
    s_cbranch_execz L_fin
    s_waitcnt lgkmcnt(2)
    v_pk_add_f32 v[40:41], v[40:41], v[42:43]
    s_waitcnt lgkmcnt(0)
    v_pk_add_f32 v[44:45], v[44:45], v[46:47]
    v_pk_add_f32 v[40:41], v[40:41], v[44:45]
    v_add_f32 v40, v40, v41
    v_cvt_f64_f32 v[42:43], v40
    v_cmp_lt_f32 vcc, |v40|, s34
    v_fma_f64 v[42:43], v[42:43], s[14:15], v[58:59]
    v_add_u32 v43, 0xc0d00000, v43
    v_cndmask_b32 v42, 0, v42, vcc
    v_cndmask_b32 v43, v52, v43, vcc
    global_atomic_add_x2 v[44:45], v18, v[42:43], s[26:27] sc0 sc1
    v_bfi_b32 v40, v3, v23, v40
    global_store_dword v21, v40, s[26:27] sc1
    v_mov_b32 v52, 0xfffff
    s_mov_b32 s34, 0x43300000
    s_mov_b32 s35, 0x35800000
    s_waitcnt vmcnt(1)
    v_lshl_add_u64 v[44:45], v[44:45], 0, v[42:43]
    v_cmp_gt_i32 vcc, 0, v45
    v_bfe_u32 v46, v45, 20, 6
    v_bfi_b32 v45, v52, v45, s34
    s_and_b64 exec, exec, vcc
    s_cbranch_execz L_fin
    v_fma_f64 v[44:45], v[44:45], s[56:57], v[60:61]
    v_cmp_ne_u32 s[90:91], 0, v46
    v_cvt_f32_f64 v44, v[44:45]
    v_max_f32 v46, |v44|, |v38|
    v_cmp_gt_f32 vcc, s35, v46
    v_add_f32 v44, v44, v38
    s_or_b64 vcc, vcc, s[90:91]
    s_cbranch_vccnz L_fb
L_out:
    v_cvt_pk_bf16_f32 v44, v44, v44
    global_store_short v19, v44, s[22:23]
    s_cmp_lg_u32 s33, 0
    s_cbranch_scc1 L_fin
    s_and_b64 exec, exec, 1
    s_cbranch_execz L_fin
    v_mov_b32 v53, s44
    global_store_dword v0, v53, s[26:27]
L_fin:
L_end:
    s_endpgm
L_o_re:
    s_mov_b64 exec, vcc
    global_load_dwordx4 v[112:115], v17, s[26:27] offset:0 sc1
    global_load_dwordx4 v[116:119], v17, s[26:27] offset:512 sc1
    global_load_dwordx4 v[120:123], v17, s[26:27] offset:1024 sc1
    global_load_dwordx4 v[124:127], v17, s[26:27] offset:1536 sc1
    s_add_u32 s45, s45, 1
    s_cmp_lt_u32 s45, 200000
    s_cbranch_scc1 L_o_chk
    s_branch L_o_ok
L_s_re:
    s_mov_b64 exec, vcc
    s_bitcmp1_b32 s59, 1
    s_cbranch_scc1 L_s_re2
    s_bitset1_b32 s59, 1
    s_waitcnt vmcnt(1)
    v_mov_b64 v[248:249], v[136:137]
    v_mov_b64 v[250:251], v[138:139]
    s_branch L_s_chk
L_s_re2:
    global_load_dwordx4 v[248:251], v16, s[26:27] sc1
    s_add_u32 s45, s45, 1
    s_cmp_lt_u32 s45, 200000
    s_waitcnt vmcnt(0)
    s_cbranch_scc1 L_s_chk
    s_branch L_s_ok
L_stqN_s:
    global_store_dword v50, v40, s[26:27] sc1
    s_nop 1
    s_branch L_stqN_d
L_stgN_s:
    global_store_dword v50, v40, s[26:27] sc1
    s_nop 1
    s_branch L_stgN_d
L_qN_re:
    s_mov_b64 exec, vcc
    s_bitcmp1_b32 s59, 0
    s_cbranch_scc1 L_qN_re2
    s_bitset1_b32 s59, 0
    s_waitcnt vmcnt(4)
    v_mov_b64 v[96:97], v[104:105]
    v_mov_b64 v[98:99], v[106:107]
    v_mov_b64 v[100:101], v[108:109]
    v_mov_b64 v[102:103], v[110:111]
    s_branch L_qN_chk
L_qN_re2:
    global_load_dwordx4 v[96:99], v14, s[26:27] offset:-4096 sc1
    global_load_dwordx4 v[100:103], v14, s[26:27] offset:0 sc1
    s_add_u32 s45, s45, 1
    s_cmp_lt_u32 s45, 200000
    s_waitcnt vmcnt(0)
    s_cbranch_scc1 L_qN_chk
    s_branch L_qN_ok
L_stsN_s:
    global_store_dwordx4 v55, v[56:59], s[26:27] sc1
    s_nop 1
    s_branch L_stsN_d
L_dn_iN:
    global_load_dword v252, v2, s[4:5]
    global_load_dword v252, v2, s[4:5]
    s_branch L_dn_dN
L_stoN_s:
    global_store_dwordx4 v39, v[40:43], s[26:27] sc1
    s_nop 1
    s_branch L_stoN_d
L_gN_re:
    s_mov_b64 exec, vcc
    global_load_dwordx4 v[88:91], v15, s[26:27] sc1
    global_load_dwordx4 v[92:95], v22, s[26:27] sc1
    s_add_u32 s45, s45, 1
    s_cmp_lt_u32 s45, 200000
    s_waitcnt vmcnt(0)
    s_cbranch_scc1 L_gN_chk
    s_branch L_gN_ok
L_fb:
    s_mov_b64 s[96:97], exec
    s_mov_b64 s[92:93], vcc
    s_mov_b64 exec, vcc
    s_lshl_b32 s34, s32, 8
    v_subrev_u32 v46, s34, v21
    v_and_b32 v46, -16, v46
    v_mov_b32 v44, 0
    s_mov_b32 s90, 0xaaaaaaaa
    s_mov_b32 s91, s90
    s_mov_b32 s94, 0xcccccccc
    s_mov_b32 s95, s94
    s_mov_b32 s35, 0
L_fb_loop:
    global_load_dwordx4 v[48:51], v46, s[26:27] sc1
    s_waitcnt vmcnt(0)
L_fb_chk:
    v_xor_b32 v48, s40, v48
    v_xor_b32 v49, s41, v49
    v_xor_b32 v50, s42, v50
    v_xor_b32 v51, s43, v51
    v_or3_b32 v47, v48, v49, v50
    v_bitop3_b32 v47, v47, v51, v3 bitop3:0xa8
    v_cmp_ne_u32 vcc, 0, v47
    s_nop 0
    s_cbranch_vccnz L_fb_re
L_fb_ok:
    s_mov_b64 exec, s[92:93]
    v_cndmask_b32 v48, v48, v49, s[90:91]
    v_cndmask_b32 v50, v50, v51, s[90:91]
    v_cndmask_b32 v48, v48, v50, s[94:95]
    v_add_f32 v44, v44, v48
    v_add_u32 v46, 256, v46
    s_add_u32 s35, s35, 1
    s_cmp_lt_u32 s35, 32
    s_cbranch_scc1 L_fb_loop
    v_add_f32 v44, v44, v38
    s_mov_b64 exec, s[96:97]
    s_branch L_out
L_fb_re:
    s_mov_b64 exec, vcc
    global_load_dwordx4 v[48:51], v46, s[26:27] sc1
    s_add_u32 s45, s45, 1
    s_cmp_lt_u32 s45, 200000
    s_waitcnt vmcnt(0)
    s_cbranch_scc1 L_fb_chk
    s_branch L_fb_ok
L_front_I:
    s_waitcnt vmcnt(7)
    s_sub_u32 s34, s28, s33
    s_lshl_b32 s35, s34, 11
    v_add_u32 v20, s35, v18
    v_mov_b64 v[58:59], 0
    s_or_b32 s48, s31, s30
    s_cbranch_scc1 L_z_i
    global_store_dwordx2 v20, v[58:59], s[26:27] sc1
    s_branch L_z_d
L_z_i:
    global_load_dword v252, v2, s[4:5]
L_z_d:
    s_lshl_b32 s35, s34, 7
    v_add_u32 v20, s35, v22
    global_load_dwordx4 v[112:115], v11, s[6:7] nt
    v_xor_b32 v253, 4096, v11
    global_load_dwordx4 v[116:119], v253, s[6:7] nt
    v_lshlrev_b32 v144, 16, v52
    v_and_b32 v145, 0xffff0000, v52
    v_lshlrev_b32 v146, 16, v53
    v_and_b32 v147, 0xffff0000, v53
    v_lshlrev_b32 v148, 16, v54
    v_and_b32 v149, 0xffff0000, v54
    v_lshlrev_b32 v150, 16, v55
    v_and_b32 v151, 0xffff0000, v55
    v_pk_add_f32 v[40:41], v[144:145], v[146:147]
    v_pk_add_f32 v[42:43], v[148:149], v[150:151]
    v_pk_add_f32 v[40:41], v[40:41], v[42:43]
    v_add_f32 v40, v40, v41
    v_lshlrev_b32 v152, 16, v56
    v_and_b32 v153, 0xffff0000, v56
    v_add_f32_dpp v40, v40, v40 quad_perm:[1,0,3,2] row_mask:0xf bank_mask:0xf
    v_lshlrev_b32 v154, 16, v57
    v_and_b32 v155, 0xffff0000, v57
    v_add_f32_dpp v40, v40, v40 quad_perm:[2,3,0,1] row_mask:0xf bank_mask:0xf
    s_nop 1
    v_add_f32_dpp v40, v40, v40 row_half_mirror row_mask:0xf bank_mask:0xf
    s_nop 1
    v_add_f32_dpp v40, v40, v40 row_ror:8 row_mask:0xf bank_mask:0xf
    v_mov_b32 v41, v40
    s_nop 1
    v_permlane16_swap_b32 v41, v40
    v_add_f32 v40, v41, v40
    v_mov_b32 v41, v40
    s_nop 1
    v_permlane32_swap_b32 v41, v40
    v_add_f32_e64 v40, v41, v40
    v_mul_f32 v40, 0x3b000000, v40
    v_pk_add_f32 v[144:145], v[144:145], v[40:41] op_sel_hi:[1,0] neg_lo:[0,1] neg_hi:[0,1]
    v_pk_add_f32 v[146:147], v[146:147], v[40:41] op_sel_hi:[1,0] neg_lo:[0,1] neg_hi:[0,1]
    v_pk_add_f32 v[148:149], v[148:149], v[40:41] op_sel_hi:[1,0] neg_lo:[0,1] neg_hi:[0,1]
    v_pk_add_f32 v[150:151], v[150:151], v[40:41] op_sel_hi:[1,0] neg_lo:[0,1] neg_hi:[0,1]
    v_pk_mul_f32 v[42:43], v[144:145], v[144:145]
    v_pk_fma_f32 v[42:43], v[146:147], v[146:147], v[42:43]
    v_pk_fma_f32 v[42:43], v[148:149], v[148:149], v[42:43]
    v_pk_fma_f32 v[42:43], v[150:151], v[150:151], v[42:43]
    v_add_f32_e64 v42, v42, v43
    v_cvt_pk_bf16_f32 v40, v40, v40
    v_and_b32 v40, 0xffff0000, v40
    v_add_f32_dpp v42, v42, v42 quad_perm:[1,0,3,2] row_mask:0xf bank_mask:0xf
    v_pk_add_f32 v[152:153], v[152:153], v[40:41] op_sel_hi:[1,0] neg_lo:[0,1] neg_hi:[0,1]
    v_pk_add_f32 v[154:155], v[154:155], v[40:41] op_sel_hi:[1,0] neg_lo:[0,1] neg_hi:[0,1]
    v_add_f32_dpp v42, v42, v42 quad_perm:[2,3,0,1] row_mask:0xf bank_mask:0xf
    v_cvt_pk_bf16_f32 v44, v152, v153
    v_cvt_pk_bf16_f32 v45, v154, v155
    v_add_f32_dpp v42, v42, v42 row_half_mirror row_mask:0xf bank_mask:0xf
    v_lshlrev_b32 v152, 16, v44
    v_and_b32 v153, 0xffff0000, v44
    v_add_f32_dpp v42, v42, v42 row_ror:8 row_mask:0xf bank_mask:0xf
    v_mov_b32 v41, v42
    v_lshlrev_b32 v154, 16, v45
    v_and_b32 v155, 0xffff0000, v45
    v_permlane16_swap_b32 v41, v42
    v_add_f32 v42, v41, v42
    v_mov_b32 v41, v42
    s_nop 1
    v_permlane32_swap_b32 v41, v42
    v_add_f32 v42, v41, v42
    v_mul_f32 v42, 0x3b000000, v42
    v_cvt_pk_bf16_f32 v42, 0, v42
    v_add_f32 v42, 0x3727c5ac, v42
    v_cvt_pk_bf16_f32 v42, 0, v42
    v_sqrt_f32 v42, v42
    s_nop 0
    v_cvt_pk_bf16_f32 v42, 0, v42
    v_rcp_f32_e64 v42, v42
    s_nop 0
    v_pk_mul_f32 v[152:153], v[152:153], v[42:43] op_sel_hi:[1,0]
    v_pk_mul_f32 v[154:155], v[154:155], v[42:43] op_sel_hi:[1,0]
    v_cvt_pk_bf16_f32 v152, v152, v152
    v_cvt_pk_bf16_f32 v153, v153, v153
    v_cvt_pk_bf16_f32 v154, v154, v154
    v_cvt_pk_bf16_f32 v155, v155, v155
    v_and_b32 v96, v152, v4
    v_and_b32 v97, v152, v5
    v_and_b32 v98, v152, v6
    v_and_b32 v99, v152, v7
    v_and_b32 v100, v153, v4
    v_and_b32 v101, v153, v5
    v_and_b32 v102, v153, v6
    v_and_b32 v103, v153, v7
    v_and_b32 v104, v154, v4
    v_and_b32 v105, v154, v5
    v_and_b32 v106, v154, v6
    v_and_b32 v107, v154, v7
    v_and_b32 v108, v155, v4
    v_and_b32 v109, v155, v5
    v_and_b32 v110, v155, v6
    v_and_b32_e64 v111, v155, v7
    s_waitcnt vmcnt(6)
    v_xor_b32 v253, 8192, v11
    global_load_dwordx4 v[120:123], v253, s[6:7] nt
    v_xor_b32 v253, 12288, v11
    global_load_dwordx4 v[124:127], v253, s[6:7] nt
    v_mfma_f32_16x16x32_bf16 v[240:243], v[96:99], v[64:67], 0
    v_mfma_f32_16x16x32_bf16 v[240:243], v[100:103], v[68:71], v[240:243]
    s_waitcnt lgkmcnt(0)
    s_add_u32 s44, s44, 0x9e3779b1
    s_bfe_u32 s40, s44, 524288
    s_bfe_u32 s41, s44, 524296
    s_bfe_u32 s42, s44, 524304
    s_bfe_u32 s43, s44, 524312
    v_lshrrev_b32_e64 v23, 1, v2
    v_lshrrev_b32 v23, v23, s44
    v_cmp_ne_u32 vcc, s53, v255
    s_nop 0
    s_cmp_eq_u64 vcc, 0
    s_cselect_b32 s54, 1, 0
    s_cmp_lg_u32 s33, 2
    s_cselect_b32 s58, s54, 0
    s_waitcnt vmcnt(6)
    v_mfma_f32_16x16x32_bf16 v[240:243], v[104:107], v[72:75], v[240:243]
    v_mfma_f32_16x16x32_bf16 v[240:243], v[108:111], v[76:79], v[240:243]
    v_xor_b32 v253, 16384, v11
    global_load_dwordx4 v[128:131], v253, s[6:7] nt
    v_xor_b32 v253, 20480, v11
    global_load_dwordx4 v[132:135], v253, s[6:7] nt
    v_mov_b32 v49, 1
    s_nop 2
    ds_write_b128 v30, v[240:243] offset:0
    ds_add_rtn_u32 v48, v0, v49 offset:21760
    ds_read2st64_b32 v[40:41], v0 offset0:0 offset1:1
    ds_read2st64_b32 v[42:43], v0 offset0:2 offset1:3
    ds_read2st64_b32 v[44:45], v0 offset0:4 offset1:5
    ds_read2st64_b32 v[46:47], v0 offset0:6 offset1:7
    v_add_u32 v50, s46, v0
    s_cmp_eq_u32 s54, 1
    s_waitcnt lgkmcnt(4)
    v_cmp_eq_u32_sdwa vcc, v48, 3 src0_sel:BYTE_0 src1_sel:DWORD
    s_nop 0
    s_cbranch_vccnz L_stqI_l
    global_load_dword v252, v2, s[4:5]
    s_waitcnt lgkmcnt(0)
    s_branch L_stqI_d
L_stqI_l:
    s_mov_b64 exec, vcc
    s_waitcnt lgkmcnt(2)
    v_pk_add_f32 v[40:41], v[40:41], v[42:43]
    s_waitcnt lgkmcnt(0)
    v_pk_add_f32 v[44:45], v[44:45], v[46:47]
    v_pk_add_f32 v[40:41], v[40:41], v[44:45]
    v_add_f32 v40, v40, v41
    v_bfi_b32 v40, v3, v23, v40
    s_cbranch_scc0 L_stqI_s
    global_store_dword v50, v40, s[26:27]
L_stqI_d:
    s_mov_b64 exec, -1
    global_load_ushort v38, v19, s[4:5]
    v_xor_b32 v253, 24576, v11
    global_load_dwordx4 v[136:139], v253, s[6:7] nt
    v_xor_b32 v253, 28672, v11
    global_load_dwordx4 v[140:143], v253, s[6:7] nt
    v_lshrrev_b32 v43, 4, v1
    v_bfe_u32 v44, v1, 3, 1
    v_and_b32 v45, 3, v1
    v_bfe_u32 v46, v1, 2, 2
    v_and_b32 v47, 1, v46
    v_and_b32 v49, 0x70, v9
    v_and_b32 v50, 2, v1
    v_lshlrev_b32 v50, 3, v50
    v_mov_b32 v51, 0xffff
    v_lshlrev_b32 v8, v50, v51
    v_lshrrev_b32 v50, 5, v1
    v_lshrrev_b32 v32, 1, v37
    v_lshl_add_u32 v32, v50, 2, v32
    s_lshl_b32 s35, s30, 8
    v_add_u32 v32, s35, v32
    v_lshlrev_b32 v33, 8, v45
    v_lshl_add_u32 v33, v46, 4, v33
    v_lshl_add_u32 v33, v43, 6, v33
    s_lshl_b32 s35, s30, 3
    v_lshl_add_u32 v34, v45, 5, s35
    s_lshl_b32 s35, s30, 5
    v_mov_b32 v35, s35
    s_lshl_b32 s35, s30, 11
    s_addk_i32 s35, 13568
    v_lshl_add_u32 v36, v1, 2, s35
    v_add_u32 v39, s50, v37
    s_lshl_b32 s34, s30, 9
    s_addk_i32 s34, 13568
    v_add_u32 v37, s34, v37
    s_mov_b32 s36, s31
    s_lshl2_add_u32 s32, s28, s36
    s_and_b32 s34, s30, 1
    s_lshr_b32 s35, s30, 1
    s_lshl2_add_u32 s34, s34, s35
    s_lshl_b32 s35, s32, 7
    s_add_u32 s34, s34, s35
    s_lshl3_add_u32 s34, s34, s33
    s_lshl_b32 s34, s34, 7
    v_lshl_add_u32 v26, v43, 13, v49
    v_lshl_add_u32 v26, v44, 11, v26
    v_add_u32 v26, s34, v26
    v_add_u32 v27, 32768, v26
    v_add_u32 v28, 65536, v26
    v_add_u32 v29, 98304, v26
    s_add_u32 s34, s28, s33
    s_and_b32 s34, s34, 1
    s_cmp_eq_u32 s36, 3
    s_cselect_b32 s52, s34, 0
    s_sub_u32 s36, s36, s52
    s_mul_i32 s34, s28, 3
    s_add_u32 s34, s34, s36
    s_lshr_b32 s35, s28, 1
    s_add_u32 s35, s35, 24
    s_cmp_eq_u32 s36, 3
    s_cselect_b32 s34, s35, s34
    s_lshl2_add_u32 s36, s34, s30
    s_lshl_b32 s36, s36, 7
    s_add_u32 s36, s36, s33
    s_lshl_b32 s36, s36, 7
    s_addk_i32 s36, 4096
    v_lshl_add_u32 v13, v43, 10, v49
    v_lshl_add_u32 v13, v44, 13, v13
    v_add_u32 v13, s36, v13
    s_lshl_b32 s34, s34, 11
    s_add_u32 s34, s34, s37
    s_add_u32 s34, s34, 73728
    v_lshlrev_b32 v51, 5, v44
    v_xor_b32 v15, v51, v2
    v_lshl_add_u32 v15, v43, 8, v15
    v_lshl_add_u32 v15, v47, 10, v15
    v_add_u32 v15, s34, v15
    v_lshl_add_u32 v51, v43, 1, v47
    s_lshl_b32 s34, s32, 9
    s_add_u32 s34, s34, 131072
    v_lshl_add_u32 v16, v51, 6, v2
    v_add_u32 v16, s34, v16
    v_mul_u32_u24 v50, 48, v47
    v_xor_b32 v17, v50, v2
    v_lshl_add_u32 v17, v44, 6, v17
    v_lshl_add_u32 v17, v51, 11, v17
    s_lshl_b32 s34, s32, 7
    s_add_u32 s34, s34, s30
    s_lshl_b32 s34, s34, 7
    s_add_u32 s34, s34, 262144
    v_add_u32 v17, s34, v17
    s_lshl_b32 s34, s33, 5
    s_add_u32 s34, s34, s32
    s_lshl_b32 s34, s34, 8
    s_add_u32 s34, s34, 163840
    v_add_u32 v21, s34, v0
    s_mov_b32 s14, 0
    s_mov_b32 s15, 0x42700000
    s_mov_b32 s56, 0
    s_mov_b32 s57, 0x3d700000
    v_mov_b64 v[176:177], 0
    v_mov_b64 v[178:179], 0
    v_mov_b64 v[180:181], 0
    v_mov_b64 v[182:183], 0
    v_mov_b64 v[184:185], 0
    v_mov_b64 v[186:187], 0
    v_mov_b64 v[188:189], 0
    v_mov_b64 v[190:191], 0
    v_mov_b64 v[192:193], 0
    v_mov_b64 v[194:195], 0
    v_mov_b64 v[196:197], 0
    v_mov_b64 v[198:199], 0
    v_mov_b64 v[200:201], 0
    v_mov_b64 v[202:203], 0
    v_mov_b64 v[204:205], 0
    v_mov_b64 v[206:207], 0
    v_mov_b64 v[208:209], 0
    v_mov_b64 v[210:211], 0
    v_mov_b64 v[212:213], 0
    v_mov_b64 v[214:215], 0
    v_mov_b64 v[216:217], 0
    v_mov_b64 v[218:219], 0
    v_mov_b64 v[220:221], 0
    v_mov_b64 v[222:223], 0
    v_mov_b64 v[224:225], 0
    v_mov_b64 v[226:227], 0
    v_mov_b64 v[228:229], 0
    v_mov_b64 v[230:231], 0
    v_mov_b64 v[232:233], 0
    v_mov_b64 v[234:235], 0
    v_mov_b64 v[236:237], 0
    v_mov_b64 v[238:239], 0
    s_waitcnt vmcnt(8)
    s_cmp_eq_u32 s48, 0
    s_cbranch_scc0 L_f_i
    v_add_u32 v20, v20, v0
    v_and_b32 v52, v3, v23
    s_mov_b64 exec, 15
    global_store_dword v20, v52, s[26:27] sc1
    s_mov_b64 exec, -1
    s_branch L_f_d
L_f_i:
    global_load_dword v252, v2, s[4:5]
L_f_d:
    global_load_dwordx4 v[144:147], v12, s[8:9] nt
    v_xor_b32 v253, 4096, v12
    global_load_dwordx4 v[148:151], v253, s[8:9] nt
    s_waitcnt vmcnt(9)
    v_xor_b32 v253, 8192, v12
    global_load_dwordx4 v[152:155], v253, s[8:9] nt
    v_xor_b32 v253, 12288, v12
    global_load_dwordx4 v[156:159], v253, s[8:9] nt
    s_waitcnt vmcnt(9)
    global_load_ubyte v255, v254, s[24:25] sc1
    global_load_dwordx4 v[96:99], v14, s[26:27] offset:-4096 sc1
    global_load_dwordx4 v[100:103], v14, s[26:27] offset:0 sc1
    s_barrier
    v_xor_b32 v253, 16384, v12
    global_load_dwordx4 v[160:163], v253, s[8:9] nt
    v_xor_b32 v253, 20480, v12
    global_load_dwordx4 v[164:167], v253, s[8:9] nt
    s_waitcnt vmcnt(10)
    v_xor_b32 v253, 24576, v12
    global_load_dwordx4 v[168:171], v253, s[8:9] nt
    v_xor_b32 v253, 28672, v12
    global_load_dwordx4 v[172:175], v253, s[8:9] nt
    global_load_dwordx4 v[104:107], v14, s[26:27] offset:-4096 sc1
    global_load_dwordx4 v[108:111], v14, s[26:27] offset:0 sc1
    s_waitcnt vmcnt(6)
L_qI_chk:
    v_xor_b32 v96, s40, v96
    v_xor_b32 v97, s41, v97
    v_xor_b32 v98, s42, v98
    v_xor_b32 v99, s43, v99
    v_xor_b32 v100, s40, v100
    v_xor_b32 v101, s41, v101
    v_xor_b32 v102, s42, v102
    v_xor_b32 v103, s43, v103
    v_or3_b32 v40, v96, v97, v98
    v_or3_b32 v40, v40, v99, v100
    v_or3_b32 v40, v40, v101, v102
    v_bitop3_b32 v40, v40, v103, v3 bitop3:0xa8
    v_cmp_ne_u32 vcc, 0, v40
    s_nop 0
    s_cbranch_vccnz L_qI_re
L_qI_ok:
    s_mov_b64 exec, -1
    v_pk_add_f32 v[96:97], v[96:97], v[100:101]
    v_pk_add_f32 v[98:99], v[98:99], v[102:103]
    v_cmp_ne_u32 vcc, s53, v255
    s_nop 0
    v_permlane32_swap_b32 v96, v98
    v_permlane32_swap_b32 v97, v99
    v_pk_add_f32 v[96:97], v[96:97], v[98:99]
    v_cvt_pk_bf16_f32 v96, v96, v97
    ds_write_b32 v32, v96 offset:12288
    s_cmp_eq_u64 vcc, 0
    s_cselect_b32 s54, 1, 0
    s_waitcnt lgkmcnt(0)
    s_barrier
    ds_read_b128 v[100:103], v33 offset:12288
    global_load_dwordx4 v[88:91], v15, s[26:27] sc1
    global_load_dwordx4 v[92:95], v22, s[26:27] sc1
    s_cmp_eq_u32 s52, 1
    s_cbranch_scc1 L_dn_iI
    global_load_dwordx4 v[80:83], v13, s[20:21] offset:-4096 nt
    global_load_dwordx4 v[84:87], v13, s[20:21] offset:0 nt
L_dn_dI:
    s_waitcnt lgkmcnt(0)
    v_mfma_f32_16x16x32_bf16 v[240:243], v[112:115], v[100:103], 0
    v_mfma_f32_16x16x32_bf16 v[112:115], v[116:119], v[100:103], 0
    v_mfma_f32_16x16x32_bf16 v[116:119], v[120:123], v[100:103], 0
    v_mfma_f32_16x16x32_bf16 v[120:123], v[124:127], v[100:103], 0
    v_mfma_f32_16x16x32_bf16 v[124:127], v[128:131], v[100:103], 0
    v_mfma_f32_16x16x32_bf16 v[128:131], v[132:135], v[100:103], 0
    v_mfma_f32_16x16x32_bf16 v[132:135], v[136:139], v[100:103], 0
    v_mfma_f32_16x16x32_bf16 v[136:139], v[140:143], v[100:103], 0
    s_nop 0
    v_add_f32_dpp v40, v241, v240 row_ror:12 row_mask:0xf bank_mask:0x1
    v_add_f32_dpp v40, v242, v40 row_ror:8 row_mask:0xf bank_mask:0x1
    v_add_f32_dpp v40, v243, v40 row_ror:4 row_mask:0xf bank_mask:0x1
    v_add_f32_dpp v40, v112, v113 row_ror:4 row_mask:0xf bank_mask:0x2
    v_add_f32_dpp v40, v114, v40 row_ror:12 row_mask:0xf bank_mask:0x2
    v_add_f32_dpp v40, v115, v40 row_ror:8 row_mask:0xf bank_mask:0x2
    v_add_f32_dpp v40, v116, v118 row_ror:8 row_mask:0xf bank_mask:0x4
    v_add_f32_dpp v40, v117, v40 row_ror:4 row_mask:0xf bank_mask:0x4
    v_add_f32_dpp v40, v119, v40 row_ror:12 row_mask:0xf bank_mask:0x4
    v_add_f32_dpp v40, v120, v123 row_ror:12 row_mask:0xf bank_mask:0x8
    v_add_f32_dpp v40, v121, v40 row_ror:8 row_mask:0xf bank_mask:0x8
    v_add_f32_dpp v40, v122, v40 row_ror:4 row_mask:0xf bank_mask:0x8
    v_add_f32_dpp v41, v125, v124 row_ror:12 row_mask:0xf bank_mask:0x1
    v_add_f32_dpp v41, v126, v41 row_ror:8 row_mask:0xf bank_mask:0x1
    v_add_f32_dpp v41, v127, v41 row_ror:4 row_mask:0xf bank_mask:0x1
    v_add_f32_dpp v41, v128, v129 row_ror:4 row_mask:0xf bank_mask:0x2
    v_add_f32_dpp v41, v130, v41 row_ror:12 row_mask:0xf bank_mask:0x2
    v_add_f32_dpp v41, v131, v41 row_ror:8 row_mask:0xf bank_mask:0x2
    v_add_f32_dpp v41, v132, v134 row_ror:8 row_mask:0xf bank_mask:0x4
    v_add_f32_dpp v41, v133, v41 row_ror:4 row_mask:0xf bank_mask:0x4
    v_add_f32_dpp v41, v135, v41 row_ror:12 row_mask:0xf bank_mask:0x4
    v_add_f32_dpp v41, v136, v139 row_ror:12 row_mask:0xf bank_mask:0x8
    v_add_f32_dpp v41, v137, v41 row_ror:8 row_mask:0xf bank_mask:0x8
    v_add_f32_dpp v41, v138, v41 row_ror:4 row_mask:0xf bank_mask:0x8
    v_cvt_pk_bf16_f32 v40, 0, v40
    v_cvt_pk_bf16_f32 v41, 0, v41
    v_mul_f32 v40, 0x3db504f3, v40
    v_mul_f32 v41, 0x3db504f3, v41
    v_cvt_pk_bf16_f32 v40, 0, v40
    v_cvt_pk_bf16_f32 v41, 0, v41
    v_max_f32 v44, v40, v41
    s_nop 1
    v_max_f32_dpp v44, v44, v44 row_ror:4 row_mask:0xf bank_mask:0xf
    s_nop 1
    v_max_f32_dpp v44, v44, v44 row_ror:8 row_mask:0xf bank_mask:0xf
    v_mov_b32 v43, v44
    s_nop 1
    v_permlane16_swap_b32 v43, v44
    v_max_f32 v44, v43, v44
    v_mov_b32 v43, v44
    s_nop 1
    v_permlane32_swap_b32 v43, v44
    v_max_f32 v44, v43, v44
    v_sub_f32 v40, v40, v44
    v_sub_f32 v41, v41, v44
    v_mul_f32 v40, 0x3fb8aa3b, v40
    v_mul_f32 v41, 0x3fb8aa3b, v41
    v_exp_f32 v40, v40
    v_exp_f32 v41, v41
    global_load_dwordx4 v[64:67], v26, s[12:13] nt
    v_add_f32 v45, v40, v41
    v_cvt_pk_bf16_f32 v40, v40, v40
    v_cvt_pk_bf16_f32 v41, v41, v41
    v_add_f32_dpp v45, v45, v45 row_ror:4 row_mask:0xf bank_mask:0xf
    v_and_b32_dpp v60, v40, v8 quad_perm:[0,1,0,1] row_mask:0xf bank_mask:0xf
    v_and_b32_dpp v61, v40, v8 quad_perm:[2,3,2,3] row_mask:0xf bank_mask:0xf
    v_and_b32_dpp v62, v41, v8 quad_perm:[0,1,0,1] row_mask:0xf bank_mask:0xf
    v_and_b32_dpp v63, v41, v8 quad_perm:[2,3,2,3] row_mask:0xf bank_mask:0xf
    v_add_f32_dpp v45, v45, v45 row_ror:8 row_mask:0xf bank_mask:0xf
    v_mov_b32 v43, v45
    v_mov_b32_dpp v176, v60 quad_perm:[0,1,2,3] row_mask:0xf bank_mask:0x1
    v_mov_b32_dpp v177, v60 row_ror:4 row_mask:0xf bank_mask:0x2
    v_permlane16_swap_b32 v43, v45
    v_add_f32 v45, v43, v45
    v_mov_b32 v43, v45
    v_mov_b32_dpp v178, v60 row_ror:8 row_mask:0xf bank_mask:0x4
    v_mov_b32_dpp v179, v60 row_ror:12 row_mask:0xf bank_mask:0x8
    v_permlane32_swap_b32 v43, v45
    v_add_f32 v45, v43, v45
    ds_write_b64 v34, v[44:45] offset:13312
    v_mov_b32_dpp v180, v61 quad_perm:[0,1,2,3] row_mask:0xf bank_mask:0x1
    v_mov_b32_dpp v181, v61 row_ror:4 row_mask:0xf bank_mask:0x2
    v_mov_b32_dpp v182, v61 row_ror:8 row_mask:0xf bank_mask:0x4
    v_mov_b32_dpp v183, v61 row_ror:12 row_mask:0xf bank_mask:0x8
    v_mov_b32_dpp v184, v60 row_ror:12 row_mask:0xf bank_mask:0x1
    v_mov_b32_dpp v185, v60 quad_perm:[0,1,2,3] row_mask:0xf bank_mask:0x2
    v_mov_b32_dpp v186, v60 row_ror:4 row_mask:0xf bank_mask:0x4
    v_mov_b32_dpp v187, v60 row_ror:8 row_mask:0xf bank_mask:0x8
    v_mov_b32_dpp v188, v61 row_ror:12 row_mask:0xf bank_mask:0x1
    v_mov_b32_dpp v189, v61 quad_perm:[0,1,2,3] row_mask:0xf bank_mask:0x2
    v_mov_b32_dpp v190, v61 row_ror:4 row_mask:0xf bank_mask:0x4
    v_mov_b32_dpp v191, v61 row_ror:8 row_mask:0xf bank_mask:0x8
    v_mov_b32_dpp v192, v60 row_ror:8 row_mask:0xf bank_mask:0x1
    v_mov_b32_dpp v193, v60 row_ror:12 row_mask:0xf bank_mask:0x2
    v_mov_b32_dpp v194, v60 quad_perm:[0,1,2,3] row_mask:0xf bank_mask:0x4
    v_mov_b32_dpp v195, v60 row_ror:4 row_mask:0xf bank_mask:0x8
    s_waitcnt lgkmcnt(0)
    s_barrier
    ds_read_b128 v[128:131], v35 offset:13312
    ds_read_b128 v[132:135], v35 offset:13328
    v_mov_b32 v58, s42
    v_mov_b32 v59, s43
    v_mov_b32 v55, s49
    s_cmp_eq_u32 s54, 1
    v_mov_b32_dpp v196, v61 row_ror:8 row_mask:0xf bank_mask:0x1
    v_mov_b32_dpp v197, v61 row_ror:12 row_mask:0xf bank_mask:0x2
    v_mov_b32_dpp v198, v61 quad_perm:[0,1,2,3] row_mask:0xf bank_mask:0x4
    v_mov_b32_dpp v199, v61 row_ror:4 row_mask:0xf bank_mask:0x8
    v_mov_b32_dpp v200, v60 row_ror:4 row_mask:0xf bank_mask:0x1
    v_mov_b32_dpp v201, v60 row_ror:8 row_mask:0xf bank_mask:0x2
    v_mov_b32_dpp v202, v60 row_ror:12 row_mask:0xf bank_mask:0x4
    v_mov_b32_dpp v203, v60 quad_perm:[0,1,2,3] row_mask:0xf bank_mask:0x8
    v_mov_b32_dpp v204, v61 row_ror:4 row_mask:0xf bank_mask:0x1
    v_mov_b32_dpp v205, v61 row_ror:8 row_mask:0xf bank_mask:0x2
    v_mov_b32_dpp v206, v61 row_ror:12 row_mask:0xf bank_mask:0x4
    v_mov_b32_dpp v207, v61 quad_perm:[0,1,2,3] row_mask:0xf bank_mask:0x8
    s_waitcnt lgkmcnt(0)
    v_max3_f32 v56, v128, v130, v132
    v_max_f32 v56, v56, v134
    v_sub_f32 v128, v128, v56
    v_sub_f32 v130, v130, v56
    v_sub_f32 v132, v132, v56
    v_sub_f32 v134, v134, v56
    v_mul_f32 v128, 0x3fb8aa3b, v128
    v_mul_f32 v130, 0x3fb8aa3b, v130
    v_mul_f32 v132, 0x3fb8aa3b, v132
    v_mul_f32 v134, 0x3fb8aa3b, v134
    v_exp_f32 v128, v128
    v_exp_f32 v130, v130
    v_exp_f32 v132, v132
    v_exp_f32 v134, v134
    v_mul_f32 v57, v128, v129
    v_fmac_f32 v57, v130, v131
    v_fmac_f32 v57, v132, v133
    v_fmac_f32 v57, v134, v135
    s_mov_b64 exec, 1
    v_bfi_b32 v56, v3, s40, v56
    v_bfi_b32 v57, v3, s41, v57
    s_cbranch_scc0 L_stsI_s
    global_store_dwordx4 v55, v[56:59], s[26:27]
L_stsI_d:
    s_mov_b64 exec, -1
    global_load_dwordx4 v[68:71], v27, s[12:13] nt
    s_waitcnt vmcnt(16)
    v_mfma_f32_16x16x32_bf16 v[240:243], v[176:179], v[144:147], 0
    v_mov_b32_dpp v208, v62 quad_perm:[0,1,2,3] row_mask:0xf bank_mask:0x1
    v_mov_b32_dpp v209, v62 row_ror:4 row_mask:0xf bank_mask:0x2
    v_mov_b32_dpp v210, v62 row_ror:8 row_mask:0xf bank_mask:0x4
    v_mov_b32_dpp v211, v62 row_ror:12 row_mask:0xf bank_mask:0x8
    v_mfma_f32_16x16x32_bf16 v[244:247], v[180:183], v[144:147], 0
    v_mov_b32_dpp v212, v63 quad_perm:[0,1,2,3] row_mask:0xf bank_mask:0x1
    v_mov_b32_dpp v213, v63 row_ror:4 row_mask:0xf bank_mask:0x2
    v_mov_b32_dpp v214, v63 row_ror:8 row_mask:0xf bank_mask:0x4
    v_mov_b32_dpp v215, v63 row_ror:12 row_mask:0xf bank_mask:0x8
    v_mfma_f32_16x16x32_bf16 v[240:243], v[184:187], v[148:151], v[240:243]
    v_mov_b32_dpp v216, v62 row_ror:12 row_mask:0xf bank_mask:0x1
    v_mov_b32_dpp v217, v62 quad_perm:[0,1,2,3] row_mask:0xf bank_mask:0x2
    v_mov_b32_dpp v218, v62 row_ror:4 row_mask:0xf bank_mask:0x4
    v_mov_b32_dpp v219, v62 row_ror:8 row_mask:0xf bank_mask:0x8
    v_mfma_f32_16x16x32_bf16 v[244:247], v[188:191], v[148:151], v[244:247]
    v_mov_b32_dpp v220, v63 row_ror:12 row_mask:0xf bank_mask:0x1
    v_mov_b32_dpp v221, v63 quad_perm:[0,1,2,3] row_mask:0xf bank_mask:0x2
    v_mov_b32_dpp v222, v63 row_ror:4 row_mask:0xf bank_mask:0x4
    v_mov_b32_dpp v223, v63 row_ror:8 row_mask:0xf bank_mask:0x8
    v_mfma_f32_16x16x32_bf16 v[240:243], v[192:195], v[152:155], v[240:243]
    v_mov_b32_dpp v224, v62 row_ror:8 row_mask:0xf bank_mask:0x1
    v_mov_b32_dpp v225, v62 row_ror:12 row_mask:0xf bank_mask:0x2
    v_mov_b32_dpp v226, v62 quad_perm:[0,1,2,3] row_mask:0xf bank_mask:0x4
    v_mov_b32_dpp v227, v62 row_ror:4 row_mask:0xf bank_mask:0x8
    v_mfma_f32_16x16x32_bf16 v[244:247], v[196:199], v[152:155], v[244:247]
    v_mov_b32_dpp v228, v63 row_ror:8 row_mask:0xf bank_mask:0x1
    v_mov_b32_dpp v229, v63 row_ror:12 row_mask:0xf bank_mask:0x2
    v_mov_b32_dpp v230, v63 quad_perm:[0,1,2,3] row_mask:0xf bank_mask:0x4
    v_mov_b32_dpp v231, v63 row_ror:4 row_mask:0xf bank_mask:0x8
    v_mfma_f32_16x16x32_bf16 v[240:243], v[200:203], v[156:159], v[240:243]
    v_mov_b32_dpp v232, v62 row_ror:4 row_mask:0xf bank_mask:0x1
    v_mov_b32_dpp v233, v62 row_ror:8 row_mask:0xf bank_mask:0x2
    v_mov_b32_dpp v234, v62 row_ror:12 row_mask:0xf bank_mask:0x4
    v_mov_b32_dpp v235, v62 quad_perm:[0,1,2,3] row_mask:0xf bank_mask:0x8
    v_mfma_f32_16x16x32_bf16 v[244:247], v[204:207], v[156:159], v[244:247]
    v_mov_b32_dpp v236, v63 row_ror:4 row_mask:0xf bank_mask:0x1
    v_mov_b32_dpp v237, v63 row_ror:8 row_mask:0xf bank_mask:0x2
    v_mov_b32_dpp v238, v63 row_ror:12 row_mask:0xf bank_mask:0x4
    v_mov_b32_dpp v239, v63 quad_perm:[0,1,2,3] row_mask:0xf bank_mask:0x8
    s_waitcnt vmcnt(11)
    global_load_dwordx4 v[72:75], v28, s[12:13] nt
    global_load_dwordx4 v[76:79], v29, s[12:13] nt
    v_mfma_f32_16x16x32_bf16 v[240:243], v[208:211], v[160:163], v[240:243]
    v_mfma_f32_16x16x32_bf16 v[244:247], v[212:215], v[160:163], v[244:247]
    v_mfma_f32_16x16x32_bf16 v[240:243], v[216:219], v[164:167], v[240:243]
    v_mfma_f32_16x16x32_bf16 v[244:247], v[220:223], v[164:167], v[244:247]
    s_waitcnt vmcnt(12)
    v_mfma_f32_16x16x32_bf16 v[240:243], v[224:227], v[168:171], v[240:243]
    v_mfma_f32_16x16x32_bf16 v[244:247], v[228:231], v[168:171], v[244:247]
    s_waitcnt vmcnt(11)
    v_mfma_f32_16x16x32_bf16 v[240:243], v[232:235], v[172:175], v[240:243]
    v_mfma_f32_16x16x32_bf16 v[244:247], v[236:239], v[172:175], v[244:247]
    s_nop 6
    ds_write2st64_b32 v36, v240, v242 offset0:0 offset1:1
    ds_write2st64_b32 v36, v241, v243 offset0:2 offset1:3
    ds_write2st64_b32 v36, v244, v246 offset0:4 offset1:5
    ds_write2st64_b32 v36, v245, v247 offset0:6 offset1:7
    s_waitcnt lgkmcnt(0)
    s_barrier
    ds_read_b128 v[40:43], v37 offset:0
    ds_read_b128 v[44:47], v37 offset:2048
    ds_read_b128 v[48:51], v37 offset:4096
    ds_read_b128 v[52:55], v37 offset:6144
    s_mov_b32 exec_hi, 0
    s_cmp_eq_u32 s54, 1
    s_waitcnt lgkmcnt(3)
    v_pk_mul_f32 v[40:41], v[128:129], v[40:41] op_sel_hi:[0,1]
    v_pk_mul_f32 v[42:43], v[128:129], v[42:43] op_sel_hi:[0,1]
    s_waitcnt lgkmcnt(2)
    v_pk_fma_f32 v[40:41], v[130:131], v[44:45], v[40:41] op_sel_hi:[0,1,1]
    v_pk_fma_f32 v[42:43], v[130:131], v[46:47], v[42:43] op_sel_hi:[0,1,1]
    s_waitcnt lgkmcnt(1)
    v_pk_fma_f32 v[40:41], v[132:133], v[48:49], v[40:41] op_sel_hi:[0,1,1]
    v_pk_fma_f32 v[42:43], v[132:133], v[50:51], v[42:43] op_sel_hi:[0,1,1]
    s_waitcnt lgkmcnt(0)
    v_pk_fma_f32 v[40:41], v[134:135], v[52:53], v[40:41] op_sel_hi:[0,1,1]
    v_pk_fma_f32 v[42:43], v[134:135], v[54:55], v[42:43] op_sel_hi:[0,1,1]
    v_bfi_b32 v40, v3, s40, v40
    v_bfi_b32 v41, v3, s41, v41
    v_bfi_b32 v42, v3, s42, v42
    v_bfi_b32 v43, v3, s43, v43
    s_cbranch_scc0 L_stoI_s
    global_store_dwordx4 v39, v[40:43], s[26:27]
L_stoI_d:
    s_mov_b32 exec_hi, -1
    global_load_dwordx4 v[248:251], v16, s[26:27] sc1
    s_waitcnt vmcnt(9)
L_gI_chk:
    v_xor_b32 v88, s40, v88
    v_xor_b32 v89, s41, v89
    v_xor_b32 v90, s42, v90
    v_xor_b32 v91, s43, v91
    v_xor_b32 v92, s40, v92
    v_xor_b32 v93, s41, v93
    v_xor_b32 v94, s42, v94
    v_xor_b32 v95, s43, v95
    v_or3_b32 v44, v88, v89, v90
    v_or3_b32 v44, v44, v91, v92
    v_or3_b32 v44, v44, v93, v94
    v_bitop3_b32 v44, v44, v95, v3 bitop3:0xa8
    v_cmp_ne_u32 vcc, 0, v44
    s_nop 0
    s_cbranch_vccnz L_gI_re
L_gI_ok:
    s_mov_b64 exec, -1
    v_permlane32_swap_b32 v88, v90
    v_permlane32_swap_b32 v89, v91
    v_add_f32 v88, v88, v90
    v_add_f32 v89, v89, v91
    s_nop 1
    v_permlane16_swap_b32 v88, v89
    v_add_f32 v88, v88, v89
    v_cvt_pk_bf16_f32 v44, 0, v88
    v_mul_f32 v46, v44, v44
    v_mul_f32 v46, 0x3d372713, v46
    v_fma_f32 v46, v46, v44, v44
    v_mul_f32 v46, 0xc0135761, v46
    v_exp_f32 v46, v46
    v_mov_b64 v[240:241], 0
    v_add_f32 v46, 1.0, v46
    v_rcp_f32 v46, v46
    v_mov_b64 v[242:243], 0
    v_mul_f32_e64 v46, v46, v44
    v_cvt_pk_bf16_f32 v46, 0, v46
    v_mul_f32_dpp v45, v44, v46 row_shl:4 row_mask:0xf bank_mask:0x5
    s_nop 0
    v_mul_f32_dpp v45, v46, v44 row_shr:4 row_mask:0xf bank_mask:0xa
    v_cvt_pk_bf16_f32 v46, v45, v45
    s_nop 1
    v_and_b32_dpp v96, v46, v4 quad_perm:[0,0,0,0] row_mask:0xf bank_mask:0xf
    v_and_b32_dpp v97, v46, v5 quad_perm:[0,0,0,0] row_mask:0xf bank_mask:0xf
    v_and_b32_dpp v98, v46, v6 quad_perm:[0,0,0,0] row_mask:0xf bank_mask:0xf
    v_and_b32_dpp v99, v46, v7 quad_perm:[0,0,0,0] row_mask:0xf bank_mask:0xf
    v_and_b32_dpp v100, v46, v4 quad_perm:[1,1,1,1] row_mask:0xf bank_mask:0xf
    v_and_b32_dpp v101, v46, v5 quad_perm:[1,1,1,1] row_mask:0xf bank_mask:0xf
    v_and_b32_dpp v102, v46, v6 quad_perm:[1,1,1,1] row_mask:0xf bank_mask:0xf
    v_and_b32_dpp v103, v46, v7 quad_perm:[1,1,1,1] row_mask:0xf bank_mask:0xf
    v_mov_b32 v58, 0
    v_mov_b32 v59, 0x43304000
    v_mov_b32 v60, 0
    v_mov_b32 v61, 0xc0b80000
    v_lshlrev_b32 v38, 16, v38
    s_cmp_eq_u32 s52, 1
    s_branch L_tail
L_stqI_s:
    global_store_dword v50, v40, s[26:27] sc1
    s_nop 1
    s_branch L_stqI_d
L_qI_re:
    s_mov_b64 exec, vcc
    s_bitcmp1_b32 s59, 0
    s_cbranch_scc1 L_qI_re2
    s_bitset1_b32 s59, 0
    s_waitcnt vmcnt(0)
    v_mov_b64 v[96:97], v[104:105]
    v_mov_b64 v[98:99], v[106:107]
    v_mov_b64 v[100:101], v[108:109]
    v_mov_b64 v[102:103], v[110:111]
    s_branch L_qI_chk
L_qI_re2:
    global_load_dwordx4 v[96:99], v14, s[26:27] offset:-4096 sc1
    global_load_dwordx4 v[100:103], v14, s[26:27] offset:0 sc1
    s_add_u32 s45, s45, 1
    s_cmp_lt_u32 s45, 200000
    s_waitcnt vmcnt(0)
    s_cbranch_scc1 L_qI_chk
    s_branch L_qI_ok
L_dn_iI:
    global_load_dword v252, v2, s[4:5]
    global_load_dword v252, v2, s[4:5]
    s_branch L_dn_dI
L_stsI_s:
    global_store_dwordx4 v55, v[56:59], s[26:27] sc1
    s_nop 1
    s_branch L_stsI_d
L_stoI_s:
    global_store_dwordx4 v39, v[40:43], s[26:27] sc1
    s_nop 1
    s_branch L_stoI_d
L_gI_re:
    s_mov_b64 exec, vcc
    global_load_dwordx4 v[88:91], v15, s[26:27] sc1
    global_load_dwordx4 v[92:95], v22, s[26:27] sc1
    s_add_u32 s45, s45, 1
    s_cmp_lt_u32 s45, 200000
    s_waitcnt vmcnt(0)
    s_cbranch_scc1 L_gI_chk
    s_branch L_gI_ok
    .fill (16384 + 64 - (. - parallel_sum__sliding_block_cached__glu_gated_geglu__decode_kernel)) / 4, 4, 0xbf810000

.section .rodata,"a"
.p2align 6
.amdhsa_kernel parallel_sum__sliding_block_cached__glu_gated_geglu__decode_kernel
  .amdhsa_next_free_vgpr 256
  .amdhsa_next_free_sgpr 100
  .amdhsa_accum_offset 256
  .amdhsa_group_segment_fixed_size 0
  .amdhsa_kernarg_size 96
  .amdhsa_user_sgpr_count 2
  .amdhsa_user_sgpr_kernarg_segment_ptr 1
  .amdhsa_system_sgpr_workgroup_id_x 1
  .amdhsa_float_denorm_mode_32 3
.end_amdhsa_kernel
```
